```python
import torch

def _softmax(x, axis=-1):
    return torch.softmax(x, dim=axis)
def _gelu(x):
    return torch.nn.functional.gelu(x, approximate="tanh")
def _silu(x):
    return torch.nn.functional.silu(x)
def _sigmoid(x):
    return torch.sigmoid(x)
def _layernorm(x, axis=-1, eps=1e-5):
    m = x.mean(dim=axis, keepdim=True)
    v = x.var(dim=axis, keepdim=True, unbiased=False)
    return (x - m) / torch.sqrt(v + eps)
def _scatter_add(tgt, idx, src, axis=0):
    return tgt.clone().index_add_(axis, idx, src)
def _segment_sum(src, seg, n):
    out = torch.zeros((n,) + src.shape[1:], dtype=src.dtype)
    return out.index_add_(0, seg, src)
def _pad(x, pw):
    flat = tuple(v for pair in reversed(pw) for v in pair)
    return torch.nn.functional.pad(x, flat)

kernel_name = 'standalone__sliding_block_cached__decode'

def setup_inputs():

    _w = (lambda a: (lambda t: t.to(torch.bfloat16) if t.is_floating_point() else t)(torch.as_tensor(a)))
    B, Sq, D = 2, 1, 640
    Hq, Hkv, Sk, Dh = 32, 32, 16384, 192
    assert Hq % Hkv == 0, (Hq, Hkv)
    return {
        "x": _w((lambda *s: torch.randn(*s, dtype=torch.bfloat16) * 1.6)(B, Sq, D)),
        "k_cache": _w((lambda *s: torch.randn(*s, dtype=torch.bfloat16) * 1.6)(B, Hkv, Sk, Dh)),
        "v_cache": _w((lambda *s: torch.randn(*s, dtype=torch.bfloat16) * 0.05)(B, Hkv, Sk, Dh)),
        "wq": _w((lambda *s: torch.randn(*s, dtype=torch.bfloat16) * 1.6)(D, Hq * Dh) * (D ** -0.5)),
        "wo": _w((lambda *s: torch.randn(*s, dtype=torch.bfloat16) * 0.05)(Hq * Dh, D) * ((Hq * Dh) ** -0.5)),
    }

def reference(x, k_cache, v_cache, wq, wo):
    B, Sq, D = x.shape
    Hq, Dh = 32, 192
    Hkv, Sk = k_cache.shape[1], k_cache.shape[2]
    W = min(4096, max(256, Sk // 4))
    rep = Hq // Hkv
    q = (lambda x, *d: x.permute(*d))((x @ wq).reshape(B, Sq, Hq, Dh), 0, 2, 1, 3)
    k = (lambda x, n, axis: torch.repeat_interleave(x, n, dim=axis))(k_cache[:, :, Sk - W:, :], rep, axis=1)
    v = (lambda x, n, axis: torch.repeat_interleave(x, n, dim=axis))(v_cache[:, :, Sk - W:, :], rep, axis=1)
    scores = torch.einsum("bhqd,bhkd->bhqk", q, k) * (Dh ** -0.5)
    p = _softmax(scores, axis=-1)
    o = torch.einsum("bhqk,bhkd->bhqd", p, v)
    return (lambda x, *d: x.permute(*d))(o, 0, 2, 1, 3).reshape(B, Sq, Hq * Dh) @ wo
```

```asm
; @launch grid=(256,1,1) block=(512,1,1) lds=43008
.amdgcn_target "amdgcn-amd-amdhsa--gfx950"
.text
.globl standalone__sliding_block_cached__decode_kernel
.p2align 8
.type standalone__sliding_block_cached__decode_kernel,@function
standalone__sliding_block_cached__decode_kernel:
    s_cmp_ge_u32 s2, 256
    s_cbranch_scc1 L_end
    s_load_dwordx16 s[4:19], s[0:1], 0
    s_lshr_b32 s78, s2, 3
    s_and_b32 s82, s2, 7
    s_lshr_b32 s83, s82, 2
    s_xor_b32 s83, s83, s82
    s_and_b32 s83, s83, 1
    s_lshl_b32 s83, s83, 2
    s_lshr_b32 s82, s82, 1
    s_add_u32 s79, s82, s83
    s_lshr_b32 s80, s79, 2
    s_lshl_b32 s94, s78, 3
    s_add_u32 s94, s94, s79
    s_lshr_b32 s49, s79, 1
    s_and_b32 s50, s79, 1
    v_and_b32 v1, 63, v0
    v_lshrrev_b32 v9, 6, v0
    v_lshrrev_b32 v10, 3, v1
    v_and_b32 v11, 7, v1
    v_readfirstlane_b32 s81, v9
    v_lshlrev_b32 v11, 4, v11
    v_mul_u32_u24 v2, 384, v10
    v_add_u32 v2, v2, v11
    v_mul_u32_u24 v3, 122880, v10
    v_add_u32 v3, v3, v11
    v_mul_u32_u24 v9, 20, v10
    v_mov_b32 v10, 0
    v_lshlrev_b32 v11, 2, v1
    s_mov_b64 exec, 0xffff
    ds_write_b32 v11, v10 offset:42048
    s_mov_b64 exec, -1
    s_mov_b32 s52, 0
    s_mov_b32 s53, 3072
    s_mov_b32 s54, 6144
    s_mov_b32 s55, 9216
    s_mov_b32 s56, 12288
    s_mov_b32 s57, 15360
    s_mov_b32 s58, 18432
    s_mov_b32 s59, 21504
    s_mov_b32 s60, 24576
    s_mov_b32 s61, 27648
    s_mov_b32 s62, 30720
    s_mov_b32 s63, 33792
    s_mov_b32 s64, 36864
    s_mov_b32 s65, 39936
    s_mov_b32 s66, 43008
    s_mov_b32 s67, 46080
    s_mov_b32 s68, 0
    s_mov_b32 s69, 12288
    s_mov_b32 s70, 24576
    s_mov_b32 s71, 36864
    s_mov_b32 s72, 49152
    s_mov_b32 s73, 61440
    s_mov_b32 s74, 73728
    s_mov_b32 s75, 86016
    s_mov_b32 s76, 98304
    s_mov_b32 s77, 110592
    v_mov_b32 v8, v2
    s_sub_u32 s82, s81, 1
    s_mul_i32 s82, s82, 49152
    s_sub_u32 s83, s81, 3
    s_max_i32 s83, s83, 0
    s_mul_i32 s83, s83, 24576
    s_add_u32 s83, s83, 147456
    s_sub_u32 s84, s81, 1
    s_cmp_lt_u32 s84, 3
    s_cselect_b32 s82, s82, s83
    s_and_b32 s83, s79, 3
    s_mul_i32 s83, s83, 270336
    s_add_u32 s82, s82, s83
    v_add_u32 v2, s82, v2
    s_mul_i32 s84, s79, 160
    v_add_u32 v9, s84, v9
    s_lshl_b32 s82, s80, 5
    s_add_u32 s82, s82, s78
    s_mul_i32 s51, s82, 16640
    s_add_u32 s51, s51, 6291456
    s_mul_i32 s82, s82, 6291456
    s_add_u32 s82, s82, 4718592
    s_mul_i32 s83, s78, 384
    s_mul_i32 s85, s79, 983040
    s_add_u32 s83, s83, s85
    s_mul_i32 s84, s78, 245760
    s_mul_i32 s85, s49, 61440
    s_add_u32 s84, s84, s85
    s_mul_i32 s85, s50, 640
    s_add_u32 s84, s84, s85
    s_waitcnt lgkmcnt(0)
    s_add_u32 s20, s6, s82
    s_addc_u32 s21, s7, 0
    s_mov_b32 s22, 1572864
    s_mov_b32 s23, 0x00020000
    s_cmp_eq_u32 s81, 0
    s_cbranch_scc0 L_main
    s_mov_b32 s40, s18
    s_mov_b32 s41, s19
    s_mov_b32 s42, 1610612736
    s_mov_b32 s43, 0x00020000
    s_mov_b32 s32, s4
    s_mov_b32 s33, s5
    s_mov_b32 s34, 2560
    s_mov_b32 s35, 0x00020000
    s_add_u32 s28, s10, s83
    s_addc_u32 s29, s11, 0
    s_mov_b32 s30, 971136
    s_mov_b32 s31, 0x00020000
    v_mov_b32 v233, 0
    buffer_load_dword v232, v233, s[40:43], 0 offen sc1
    buffer_load_dwordx4 v[220:223], v9, s[32:35], 0 offen
    buffer_load_dword v224, v9, s[32:35], 0 offen offset:16
    buffer_load_dwordx4 v[184:187], v9, s[32:35], 0 offen offset:1280
    buffer_load_dword v188, v9, s[32:35], 0 offen offset:1296
    s_and_b32 s86, s79, 3
    s_cmp_eq_u32 s86, 0
    s_cbranch_scc0 L_noinit
    v_mov_b32 v10, 0
    s_mov_b64 exec, 1
    buffer_store_dword v10, v10, s[40:43], s51 offen sc1
    s_mov_b64 exec, -1
L_noinit:
    buffer_load_dwordx4 v[64:67], v3, s[28:31], s68 offen offset:0 nt
    buffer_load_dwordx4 v[68:71], v3, s[28:31], s68 offen offset:128 nt
    buffer_load_dwordx4 v[72:75], v3, s[28:31], s68 offen offset:256 nt
    buffer_load_dwordx4 v[76:79], v3, s[28:31], s69 offen offset:0 nt
    buffer_load_dwordx4 v[80:83], v3, s[28:31], s69 offen offset:128 nt
    buffer_load_dwordx4 v[84:87], v3, s[28:31], s69 offen offset:256 nt
    s_add_u32 s24, s8, s82
    s_addc_u32 s25, s9, 0
    s_mov_b32 s26, 1572864
    s_mov_b32 s27, 0x00020000
    s_add_u32 s36, s12, s84
    s_addc_u32 s37, s13, 0
    s_mov_b32 s38, 60800
    s_mov_b32 s39, 0x00020000
    s_mov_b32 s44, s14
    s_mov_b32 s45, s15
    s_mov_b32 s46, 2560
    s_mov_b32 s47, 0x00020000
    s_barrier
    buffer_load_dwordx4 v[88:91], v3, s[28:31], s70 offen offset:0 nt
    buffer_load_dwordx4 v[92:95], v3, s[28:31], s70 offen offset:128 nt
    buffer_load_dwordx4 v[96:99], v3, s[28:31], s70 offen offset:256 nt
    buffer_load_dwordx4 v[100:103], v3, s[28:31], s71 offen offset:0 nt
    buffer_load_dwordx4 v[104:107], v3, s[28:31], s71 offen offset:128 nt
    buffer_load_dwordx4 v[108:111], v3, s[28:31], s71 offen offset:256 nt
    buffer_load_dwordx4 v[112:115], v3, s[28:31], s72 offen offset:0 nt
    buffer_load_dwordx4 v[116:119], v3, s[28:31], s72 offen offset:128 nt
    buffer_load_dwordx4 v[120:123], v3, s[28:31], s72 offen offset:256 nt
    buffer_load_dwordx4 v[124:127], v3, s[28:31], s73 offen offset:0 nt
    buffer_load_dwordx4 v[128:131], v3, s[28:31], s73 offen offset:128 nt
    buffer_load_dwordx4 v[132:135], v3, s[28:31], s73 offen offset:256 nt
    buffer_load_dwordx4 v[136:139], v3, s[28:31], s74 offen offset:0 nt
    buffer_load_dwordx4 v[140:143], v3, s[28:31], s74 offen offset:128 nt
    buffer_load_dwordx4 v[144:147], v3, s[28:31], s74 offen offset:256 nt
    buffer_load_dwordx4 v[148:151], v3, s[28:31], s75 offen offset:0 nt
    buffer_load_dwordx4 v[152:155], v3, s[28:31], s75 offen offset:128 nt
    buffer_load_dwordx4 v[156:159], v3, s[28:31], s75 offen offset:256 nt
    buffer_load_dwordx4 v[160:163], v3, s[28:31], s76 offen offset:0 nt
    buffer_load_dwordx4 v[164:167], v3, s[28:31], s76 offen offset:128 nt
    buffer_load_dwordx4 v[168:171], v3, s[28:31], s76 offen offset:256 nt
    buffer_load_dwordx4 v[172:175], v3, s[28:31], s77 offen offset:0 nt
    buffer_load_dwordx4 v[176:179], v3, s[28:31], s77 offen offset:128 nt
    buffer_load_dwordx4 v[180:183], v3, s[28:31], s77 offen offset:256 nt
    v_mov_b32 v40, 0
    v_mov_b32 v196, 0
    v_mov_b32 v41, 0
    v_mov_b32 v197, 0
    v_mov_b32 v42, 0
    v_mov_b32 v198, 0
    v_mov_b32 v43, 0
    v_mov_b32 v199, 0
    v_mov_b32 v44, 0
    v_mov_b32 v200, 0
    v_mov_b32 v45, 0
    v_mov_b32 v201, 0
    v_mov_b32 v46, 0
    v_mov_b32 v202, 0
    v_mov_b32 v47, 0
    v_mov_b32 v203, 0
    v_mov_b32 v48, 0
    v_mov_b32 v204, 0
    v_mov_b32 v49, 0
    v_mov_b32 v205, 0
    v_mov_b32 v50, 0
    v_mov_b32 v206, 0
    v_mov_b32 v51, 0
    v_mov_b32 v207, 0
    v_mov_b32 v52, 0
    v_mov_b32 v208, 0
    v_mov_b32 v53, 0
    v_mov_b32 v209, 0
    v_mov_b32 v54, 0
    v_mov_b32 v210, 0
    v_mov_b32 v55, 0
    v_mov_b32 v211, 0
    v_mov_b32 v56, 0
    v_mov_b32 v212, 0
    v_mov_b32 v57, 0
    v_mov_b32 v213, 0
    v_mov_b32 v58, 0
    v_mov_b32 v214, 0
    v_mov_b32 v59, 0
    v_mov_b32 v215, 0
    v_mov_b32 v60, 0
    v_mov_b32 v216, 0
    v_mov_b32 v61, 0
    v_mov_b32 v217, 0
    v_mov_b32 v62, 0
    v_mov_b32 v218, 0
    v_mov_b32 v63, 0
    v_mov_b32 v219, 0
    s_waitcnt vmcnt(27)
    v_and_b32 v9, 0xffff, v220
    v_lshlrev_b32 v10, 16, v220
    v_and_b32 v190, 0xffff, v184
    v_lshlrev_b32 v191, 16, v184
    v_dot2c_f32_bf16 v40, v64, v9
    v_dot2c_f32_bf16 v41, v64, v10
    v_dot2c_f32_bf16 v42, v65, v9
    v_dot2c_f32_bf16 v43, v65, v10
    v_dot2c_f32_bf16 v44, v66, v9
    v_dot2c_f32_bf16 v45, v66, v10
    v_dot2c_f32_bf16 v46, v67, v9
    v_dot2c_f32_bf16 v47, v67, v10
    v_dot2c_f32_bf16 v48, v68, v9
    v_dot2c_f32_bf16 v49, v68, v10
    v_dot2c_f32_bf16 v50, v69, v9
    v_dot2c_f32_bf16 v51, v69, v10
    v_dot2c_f32_bf16 v52, v70, v9
    v_dot2c_f32_bf16 v53, v70, v10
    v_dot2c_f32_bf16 v54, v71, v9
    v_dot2c_f32_bf16 v55, v71, v10
    v_dot2c_f32_bf16 v56, v72, v9
    v_dot2c_f32_bf16 v57, v72, v10
    v_dot2c_f32_bf16 v58, v73, v9
    v_dot2c_f32_bf16 v59, v73, v10
    v_dot2c_f32_bf16 v60, v74, v9
    v_dot2c_f32_bf16 v61, v74, v10
    v_dot2c_f32_bf16 v62, v75, v9
    v_dot2c_f32_bf16 v63, v75, v10
    v_dot2c_f32_bf16 v196, v64, v190
    v_dot2c_f32_bf16 v197, v64, v191
    v_dot2c_f32_bf16 v198, v65, v190
    v_dot2c_f32_bf16 v199, v65, v191
    v_dot2c_f32_bf16 v200, v66, v190
    v_dot2c_f32_bf16 v201, v66, v191
    v_dot2c_f32_bf16 v202, v67, v190
    v_dot2c_f32_bf16 v203, v67, v191
    v_dot2c_f32_bf16 v204, v68, v190
    v_dot2c_f32_bf16 v205, v68, v191
    v_dot2c_f32_bf16 v206, v69, v190
    v_dot2c_f32_bf16 v207, v69, v191
    v_dot2c_f32_bf16 v208, v70, v190
    v_dot2c_f32_bf16 v209, v70, v191
    v_dot2c_f32_bf16 v210, v71, v190
    v_dot2c_f32_bf16 v211, v71, v191
    v_dot2c_f32_bf16 v212, v72, v190
    v_dot2c_f32_bf16 v213, v72, v191
    v_dot2c_f32_bf16 v214, v73, v190
    v_dot2c_f32_bf16 v215, v73, v191
    v_dot2c_f32_bf16 v216, v74, v190
    v_dot2c_f32_bf16 v217, v74, v191
    v_dot2c_f32_bf16 v218, v75, v190
    v_dot2c_f32_bf16 v219, v75, v191
    s_waitcnt vmcnt(24)
    v_lshrrev_b32 v9, 16, v220
    v_and_b32 v10, 0xffff0000, v220
    v_lshrrev_b32 v190, 16, v184
    v_and_b32 v191, 0xffff0000, v184
    v_dot2c_f32_bf16 v40, v76, v9
    v_dot2c_f32_bf16 v41, v76, v10
    v_dot2c_f32_bf16 v42, v77, v9
    v_dot2c_f32_bf16 v43, v77, v10
    v_dot2c_f32_bf16 v44, v78, v9
    v_dot2c_f32_bf16 v45, v78, v10
    v_dot2c_f32_bf16 v46, v79, v9
    v_dot2c_f32_bf16 v47, v79, v10
    v_dot2c_f32_bf16 v48, v80, v9
    v_dot2c_f32_bf16 v49, v80, v10
    v_dot2c_f32_bf16 v50, v81, v9
    v_dot2c_f32_bf16 v51, v81, v10
    v_dot2c_f32_bf16 v52, v82, v9
    v_dot2c_f32_bf16 v53, v82, v10
    v_dot2c_f32_bf16 v54, v83, v9
    v_dot2c_f32_bf16 v55, v83, v10
    v_dot2c_f32_bf16 v56, v84, v9
    v_dot2c_f32_bf16 v57, v84, v10
    v_dot2c_f32_bf16 v58, v85, v9
    v_dot2c_f32_bf16 v59, v85, v10
    v_dot2c_f32_bf16 v60, v86, v9
    v_dot2c_f32_bf16 v61, v86, v10
    v_dot2c_f32_bf16 v62, v87, v9
    v_dot2c_f32_bf16 v63, v87, v10
    v_dot2c_f32_bf16 v196, v76, v190
    v_dot2c_f32_bf16 v197, v76, v191
    v_dot2c_f32_bf16 v198, v77, v190
    v_dot2c_f32_bf16 v199, v77, v191
    v_dot2c_f32_bf16 v200, v78, v190
    v_dot2c_f32_bf16 v201, v78, v191
    v_dot2c_f32_bf16 v202, v79, v190
    v_dot2c_f32_bf16 v203, v79, v191
    v_dot2c_f32_bf16 v204, v80, v190
    v_dot2c_f32_bf16 v205, v80, v191
    v_dot2c_f32_bf16 v206, v81, v190
    v_dot2c_f32_bf16 v207, v81, v191
    v_dot2c_f32_bf16 v208, v82, v190
    v_dot2c_f32_bf16 v209, v82, v191
    v_dot2c_f32_bf16 v210, v83, v190
    v_dot2c_f32_bf16 v211, v83, v191
    v_dot2c_f32_bf16 v212, v84, v190
    v_dot2c_f32_bf16 v213, v84, v191
    v_dot2c_f32_bf16 v214, v85, v190
    v_dot2c_f32_bf16 v215, v85, v191
    v_dot2c_f32_bf16 v216, v86, v190
    v_dot2c_f32_bf16 v217, v86, v191
    v_dot2c_f32_bf16 v218, v87, v190
    v_dot2c_f32_bf16 v219, v87, v191
    s_waitcnt vmcnt(21)
    v_and_b32 v9, 0xffff, v221
    v_lshlrev_b32 v10, 16, v221
    v_and_b32 v190, 0xffff, v185
    v_lshlrev_b32 v191, 16, v185
    v_dot2c_f32_bf16 v40, v88, v9
    v_dot2c_f32_bf16 v41, v88, v10
    v_dot2c_f32_bf16 v42, v89, v9
    v_dot2c_f32_bf16 v43, v89, v10
    v_dot2c_f32_bf16 v44, v90, v9
    v_dot2c_f32_bf16 v45, v90, v10
    v_dot2c_f32_bf16 v46, v91, v9
    v_dot2c_f32_bf16 v47, v91, v10
    v_dot2c_f32_bf16 v48, v92, v9
    v_dot2c_f32_bf16 v49, v92, v10
    v_dot2c_f32_bf16 v50, v93, v9
    v_dot2c_f32_bf16 v51, v93, v10
    v_dot2c_f32_bf16 v52, v94, v9
    v_dot2c_f32_bf16 v53, v94, v10
    v_dot2c_f32_bf16 v54, v95, v9
    v_dot2c_f32_bf16 v55, v95, v10
    v_dot2c_f32_bf16 v56, v96, v9
    v_dot2c_f32_bf16 v57, v96, v10
    v_dot2c_f32_bf16 v58, v97, v9
    v_dot2c_f32_bf16 v59, v97, v10
    v_dot2c_f32_bf16 v60, v98, v9
    v_dot2c_f32_bf16 v61, v98, v10
    v_dot2c_f32_bf16 v62, v99, v9
    v_dot2c_f32_bf16 v63, v99, v10
    v_dot2c_f32_bf16 v196, v88, v190
    v_dot2c_f32_bf16 v197, v88, v191
    v_dot2c_f32_bf16 v198, v89, v190
    v_dot2c_f32_bf16 v199, v89, v191
    v_dot2c_f32_bf16 v200, v90, v190
    v_dot2c_f32_bf16 v201, v90, v191
    v_dot2c_f32_bf16 v202, v91, v190
    v_dot2c_f32_bf16 v203, v91, v191
    v_dot2c_f32_bf16 v204, v92, v190
    v_dot2c_f32_bf16 v205, v92, v191
    v_dot2c_f32_bf16 v206, v93, v190
    v_dot2c_f32_bf16 v207, v93, v191
    v_dot2c_f32_bf16 v208, v94, v190
    v_dot2c_f32_bf16 v209, v94, v191
    v_dot2c_f32_bf16 v210, v95, v190
    v_dot2c_f32_bf16 v211, v95, v191
    v_dot2c_f32_bf16 v212, v96, v190
    v_dot2c_f32_bf16 v213, v96, v191
    v_dot2c_f32_bf16 v214, v97, v190
    v_dot2c_f32_bf16 v215, v97, v191
    v_dot2c_f32_bf16 v216, v98, v190
    v_dot2c_f32_bf16 v217, v98, v191
    v_dot2c_f32_bf16 v218, v99, v190
    v_dot2c_f32_bf16 v219, v99, v191
    s_waitcnt vmcnt(18)
    v_lshrrev_b32 v9, 16, v221
    v_and_b32 v10, 0xffff0000, v221
    v_lshrrev_b32 v190, 16, v185
    v_and_b32 v191, 0xffff0000, v185
    v_dot2c_f32_bf16 v40, v100, v9
    v_dot2c_f32_bf16 v41, v100, v10
    v_dot2c_f32_bf16 v42, v101, v9
    v_dot2c_f32_bf16 v43, v101, v10
    v_dot2c_f32_bf16 v44, v102, v9
    v_dot2c_f32_bf16 v45, v102, v10
    v_dot2c_f32_bf16 v46, v103, v9
    v_dot2c_f32_bf16 v47, v103, v10
    v_dot2c_f32_bf16 v48, v104, v9
    v_dot2c_f32_bf16 v49, v104, v10
    v_dot2c_f32_bf16 v50, v105, v9
    v_dot2c_f32_bf16 v51, v105, v10
    v_dot2c_f32_bf16 v52, v106, v9
    v_dot2c_f32_bf16 v53, v106, v10
    v_dot2c_f32_bf16 v54, v107, v9
    v_dot2c_f32_bf16 v55, v107, v10
    v_dot2c_f32_bf16 v56, v108, v9
    v_dot2c_f32_bf16 v57, v108, v10
    v_dot2c_f32_bf16 v58, v109, v9
    v_dot2c_f32_bf16 v59, v109, v10
    v_dot2c_f32_bf16 v60, v110, v9
    v_dot2c_f32_bf16 v61, v110, v10
    v_dot2c_f32_bf16 v62, v111, v9
    v_dot2c_f32_bf16 v63, v111, v10
    v_dot2c_f32_bf16 v196, v100, v190
    v_dot2c_f32_bf16 v197, v100, v191
    v_dot2c_f32_bf16 v198, v101, v190
    v_dot2c_f32_bf16 v199, v101, v191
    v_dot2c_f32_bf16 v200, v102, v190
    v_dot2c_f32_bf16 v201, v102, v191
    v_dot2c_f32_bf16 v202, v103, v190
    v_dot2c_f32_bf16 v203, v103, v191
    v_dot2c_f32_bf16 v204, v104, v190
    v_dot2c_f32_bf16 v205, v104, v191
    v_dot2c_f32_bf16 v206, v105, v190
    v_dot2c_f32_bf16 v207, v105, v191
    v_dot2c_f32_bf16 v208, v106, v190
    v_dot2c_f32_bf16 v209, v106, v191
    v_dot2c_f32_bf16 v210, v107, v190
    v_dot2c_f32_bf16 v211, v107, v191
    v_dot2c_f32_bf16 v212, v108, v190
    v_dot2c_f32_bf16 v213, v108, v191
    v_dot2c_f32_bf16 v214, v109, v190
    v_dot2c_f32_bf16 v215, v109, v191
    v_dot2c_f32_bf16 v216, v110, v190
    v_dot2c_f32_bf16 v217, v110, v191
    v_dot2c_f32_bf16 v218, v111, v190
    v_dot2c_f32_bf16 v219, v111, v191
    s_waitcnt vmcnt(15)
    v_and_b32 v9, 0xffff, v222
    v_lshlrev_b32 v10, 16, v222
    v_and_b32 v190, 0xffff, v186
    v_lshlrev_b32 v191, 16, v186
    v_dot2c_f32_bf16 v40, v112, v9
    v_dot2c_f32_bf16 v41, v112, v10
    v_dot2c_f32_bf16 v42, v113, v9
    v_dot2c_f32_bf16 v43, v113, v10
    v_dot2c_f32_bf16 v44, v114, v9
    v_dot2c_f32_bf16 v45, v114, v10
    v_dot2c_f32_bf16 v46, v115, v9
    v_dot2c_f32_bf16 v47, v115, v10
    v_dot2c_f32_bf16 v48, v116, v9
    v_dot2c_f32_bf16 v49, v116, v10
    v_dot2c_f32_bf16 v50, v117, v9
    v_dot2c_f32_bf16 v51, v117, v10
    v_dot2c_f32_bf16 v52, v118, v9
    v_dot2c_f32_bf16 v53, v118, v10
    v_dot2c_f32_bf16 v54, v119, v9
    v_dot2c_f32_bf16 v55, v119, v10
    v_dot2c_f32_bf16 v56, v120, v9
    v_dot2c_f32_bf16 v57, v120, v10
    v_dot2c_f32_bf16 v58, v121, v9
    v_dot2c_f32_bf16 v59, v121, v10
    v_dot2c_f32_bf16 v60, v122, v9
    v_dot2c_f32_bf16 v61, v122, v10
    v_dot2c_f32_bf16 v62, v123, v9
    v_dot2c_f32_bf16 v63, v123, v10
    v_dot2c_f32_bf16 v196, v112, v190
    v_dot2c_f32_bf16 v197, v112, v191
    v_dot2c_f32_bf16 v198, v113, v190
    v_dot2c_f32_bf16 v199, v113, v191
    v_dot2c_f32_bf16 v200, v114, v190
    v_dot2c_f32_bf16 v201, v114, v191
    v_dot2c_f32_bf16 v202, v115, v190
    v_dot2c_f32_bf16 v203, v115, v191
    v_dot2c_f32_bf16 v204, v116, v190
    v_dot2c_f32_bf16 v205, v116, v191
    v_dot2c_f32_bf16 v206, v117, v190
    v_dot2c_f32_bf16 v207, v117, v191
    v_dot2c_f32_bf16 v208, v118, v190
    v_dot2c_f32_bf16 v209, v118, v191
    v_dot2c_f32_bf16 v210, v119, v190
    v_dot2c_f32_bf16 v211, v119, v191
    v_dot2c_f32_bf16 v212, v120, v190
    v_dot2c_f32_bf16 v213, v120, v191
    v_dot2c_f32_bf16 v214, v121, v190
    v_dot2c_f32_bf16 v215, v121, v191
    v_dot2c_f32_bf16 v216, v122, v190
    v_dot2c_f32_bf16 v217, v122, v191
    v_dot2c_f32_bf16 v218, v123, v190
    v_dot2c_f32_bf16 v219, v123, v191
    s_waitcnt vmcnt(12)
    v_lshrrev_b32 v9, 16, v222
    v_and_b32 v10, 0xffff0000, v222
    v_lshrrev_b32 v190, 16, v186
    v_and_b32 v191, 0xffff0000, v186
    v_dot2c_f32_bf16 v40, v124, v9
    v_dot2c_f32_bf16 v41, v124, v10
    v_dot2c_f32_bf16 v42, v125, v9
    v_dot2c_f32_bf16 v43, v125, v10
    v_dot2c_f32_bf16 v44, v126, v9
    v_dot2c_f32_bf16 v45, v126, v10
    v_dot2c_f32_bf16 v46, v127, v9
    v_dot2c_f32_bf16 v47, v127, v10
    v_dot2c_f32_bf16 v48, v128, v9
    v_dot2c_f32_bf16 v49, v128, v10
    v_dot2c_f32_bf16 v50, v129, v9
    v_dot2c_f32_bf16 v51, v129, v10
    v_dot2c_f32_bf16 v52, v130, v9
    v_dot2c_f32_bf16 v53, v130, v10
    v_dot2c_f32_bf16 v54, v131, v9
    v_dot2c_f32_bf16 v55, v131, v10
    v_dot2c_f32_bf16 v56, v132, v9
    v_dot2c_f32_bf16 v57, v132, v10
    v_dot2c_f32_bf16 v58, v133, v9
    v_dot2c_f32_bf16 v59, v133, v10
    v_dot2c_f32_bf16 v60, v134, v9
    v_dot2c_f32_bf16 v61, v134, v10
    v_dot2c_f32_bf16 v62, v135, v9
    v_dot2c_f32_bf16 v63, v135, v10
    v_dot2c_f32_bf16 v196, v124, v190
    v_dot2c_f32_bf16 v197, v124, v191
    v_dot2c_f32_bf16 v198, v125, v190
    v_dot2c_f32_bf16 v199, v125, v191
    v_dot2c_f32_bf16 v200, v126, v190
    v_dot2c_f32_bf16 v201, v126, v191
    v_dot2c_f32_bf16 v202, v127, v190
    v_dot2c_f32_bf16 v203, v127, v191
    v_dot2c_f32_bf16 v204, v128, v190
    v_dot2c_f32_bf16 v205, v128, v191
    v_dot2c_f32_bf16 v206, v129, v190
    v_dot2c_f32_bf16 v207, v129, v191
    v_dot2c_f32_bf16 v208, v130, v190
    v_dot2c_f32_bf16 v209, v130, v191
    v_dot2c_f32_bf16 v210, v131, v190
    v_dot2c_f32_bf16 v211, v131, v191
    v_dot2c_f32_bf16 v212, v132, v190
    v_dot2c_f32_bf16 v213, v132, v191
    v_dot2c_f32_bf16 v214, v133, v190
    v_dot2c_f32_bf16 v215, v133, v191
    v_dot2c_f32_bf16 v216, v134, v190
    v_dot2c_f32_bf16 v217, v134, v191
    v_dot2c_f32_bf16 v218, v135, v190
    v_dot2c_f32_bf16 v219, v135, v191
    s_waitcnt vmcnt(9)
    v_and_b32 v9, 0xffff, v223
    v_lshlrev_b32 v10, 16, v223
    v_and_b32 v190, 0xffff, v187
    v_lshlrev_b32 v191, 16, v187
    v_dot2c_f32_bf16 v40, v136, v9
    v_dot2c_f32_bf16 v41, v136, v10
    v_dot2c_f32_bf16 v42, v137, v9
    v_dot2c_f32_bf16 v43, v137, v10
    v_dot2c_f32_bf16 v44, v138, v9
    v_dot2c_f32_bf16 v45, v138, v10
    v_dot2c_f32_bf16 v46, v139, v9
    v_dot2c_f32_bf16 v47, v139, v10
    v_dot2c_f32_bf16 v48, v140, v9
    v_dot2c_f32_bf16 v49, v140, v10
    v_dot2c_f32_bf16 v50, v141, v9
    v_dot2c_f32_bf16 v51, v141, v10
    v_dot2c_f32_bf16 v52, v142, v9
    v_dot2c_f32_bf16 v53, v142, v10
    v_dot2c_f32_bf16 v54, v143, v9
    v_dot2c_f32_bf16 v55, v143, v10
    v_dot2c_f32_bf16 v56, v144, v9
    v_dot2c_f32_bf16 v57, v144, v10
    v_dot2c_f32_bf16 v58, v145, v9
    v_dot2c_f32_bf16 v59, v145, v10
    v_dot2c_f32_bf16 v60, v146, v9
    v_dot2c_f32_bf16 v61, v146, v10
    v_dot2c_f32_bf16 v62, v147, v9
    v_dot2c_f32_bf16 v63, v147, v10
    v_dot2c_f32_bf16 v196, v136, v190
    v_dot2c_f32_bf16 v197, v136, v191
    v_dot2c_f32_bf16 v198, v137, v190
    v_dot2c_f32_bf16 v199, v137, v191
    v_dot2c_f32_bf16 v200, v138, v190
    v_dot2c_f32_bf16 v201, v138, v191
    v_dot2c_f32_bf16 v202, v139, v190
    v_dot2c_f32_bf16 v203, v139, v191
    v_dot2c_f32_bf16 v204, v140, v190
    v_dot2c_f32_bf16 v205, v140, v191
    v_dot2c_f32_bf16 v206, v141, v190
    v_dot2c_f32_bf16 v207, v141, v191
    v_dot2c_f32_bf16 v208, v142, v190
    v_dot2c_f32_bf16 v209, v142, v191
    v_dot2c_f32_bf16 v210, v143, v190
    v_dot2c_f32_bf16 v211, v143, v191
    v_dot2c_f32_bf16 v212, v144, v190
    v_dot2c_f32_bf16 v213, v144, v191
    v_dot2c_f32_bf16 v214, v145, v190
    v_dot2c_f32_bf16 v215, v145, v191
    v_dot2c_f32_bf16 v216, v146, v190
    v_dot2c_f32_bf16 v217, v146, v191
    v_dot2c_f32_bf16 v218, v147, v190
    v_dot2c_f32_bf16 v219, v147, v191
    s_waitcnt vmcnt(6)
    v_lshrrev_b32 v9, 16, v223
    v_and_b32 v10, 0xffff0000, v223
    v_lshrrev_b32 v190, 16, v187
    v_and_b32 v191, 0xffff0000, v187
    v_dot2c_f32_bf16 v40, v148, v9
    v_dot2c_f32_bf16 v41, v148, v10
    v_dot2c_f32_bf16 v42, v149, v9
    v_dot2c_f32_bf16 v43, v149, v10
    v_dot2c_f32_bf16 v44, v150, v9
    v_dot2c_f32_bf16 v45, v150, v10
    v_dot2c_f32_bf16 v46, v151, v9
    v_dot2c_f32_bf16 v47, v151, v10
    v_dot2c_f32_bf16 v48, v152, v9
    v_dot2c_f32_bf16 v49, v152, v10
    v_dot2c_f32_bf16 v50, v153, v9
    v_dot2c_f32_bf16 v51, v153, v10
    v_dot2c_f32_bf16 v52, v154, v9
    v_dot2c_f32_bf16 v53, v154, v10
    v_dot2c_f32_bf16 v54, v155, v9
    v_dot2c_f32_bf16 v55, v155, v10
    v_dot2c_f32_bf16 v56, v156, v9
    v_dot2c_f32_bf16 v57, v156, v10
    v_dot2c_f32_bf16 v58, v157, v9
    v_dot2c_f32_bf16 v59, v157, v10
    v_dot2c_f32_bf16 v60, v158, v9
    v_dot2c_f32_bf16 v61, v158, v10
    v_dot2c_f32_bf16 v62, v159, v9
    v_dot2c_f32_bf16 v63, v159, v10
    v_dot2c_f32_bf16 v196, v148, v190
    v_dot2c_f32_bf16 v197, v148, v191
    v_dot2c_f32_bf16 v198, v149, v190
    v_dot2c_f32_bf16 v199, v149, v191
    v_dot2c_f32_bf16 v200, v150, v190
    v_dot2c_f32_bf16 v201, v150, v191
    v_dot2c_f32_bf16 v202, v151, v190
    v_dot2c_f32_bf16 v203, v151, v191
    v_dot2c_f32_bf16 v204, v152, v190
    v_dot2c_f32_bf16 v205, v152, v191
    v_dot2c_f32_bf16 v206, v153, v190
    v_dot2c_f32_bf16 v207, v153, v191
    v_dot2c_f32_bf16 v208, v154, v190
    v_dot2c_f32_bf16 v209, v154, v191
    v_dot2c_f32_bf16 v210, v155, v190
    v_dot2c_f32_bf16 v211, v155, v191
    v_dot2c_f32_bf16 v212, v156, v190
    v_dot2c_f32_bf16 v213, v156, v191
    v_dot2c_f32_bf16 v214, v157, v190
    v_dot2c_f32_bf16 v215, v157, v191
    v_dot2c_f32_bf16 v216, v158, v190
    v_dot2c_f32_bf16 v217, v158, v191
    v_dot2c_f32_bf16 v218, v159, v190
    v_dot2c_f32_bf16 v219, v159, v191
    s_waitcnt vmcnt(3)
    v_and_b32 v9, 0xffff, v224
    v_lshlrev_b32 v10, 16, v224
    v_and_b32 v190, 0xffff, v188
    v_lshlrev_b32 v191, 16, v188
    v_dot2c_f32_bf16 v40, v160, v9
    v_dot2c_f32_bf16 v41, v160, v10
    v_dot2c_f32_bf16 v42, v161, v9
    v_dot2c_f32_bf16 v43, v161, v10
    v_dot2c_f32_bf16 v44, v162, v9
    v_dot2c_f32_bf16 v45, v162, v10
    v_dot2c_f32_bf16 v46, v163, v9
    v_dot2c_f32_bf16 v47, v163, v10
    v_dot2c_f32_bf16 v48, v164, v9
    v_dot2c_f32_bf16 v49, v164, v10
    v_dot2c_f32_bf16 v50, v165, v9
    v_dot2c_f32_bf16 v51, v165, v10
    v_dot2c_f32_bf16 v52, v166, v9
    v_dot2c_f32_bf16 v53, v166, v10
    v_dot2c_f32_bf16 v54, v167, v9
    v_dot2c_f32_bf16 v55, v167, v10
    v_dot2c_f32_bf16 v56, v168, v9
    v_dot2c_f32_bf16 v57, v168, v10
    v_dot2c_f32_bf16 v58, v169, v9
    v_dot2c_f32_bf16 v59, v169, v10
    v_dot2c_f32_bf16 v60, v170, v9
    v_dot2c_f32_bf16 v61, v170, v10
    v_dot2c_f32_bf16 v62, v171, v9
    v_dot2c_f32_bf16 v63, v171, v10
    v_dot2c_f32_bf16 v196, v160, v190
    v_dot2c_f32_bf16 v197, v160, v191
    v_dot2c_f32_bf16 v198, v161, v190
    v_dot2c_f32_bf16 v199, v161, v191
    v_dot2c_f32_bf16 v200, v162, v190
    v_dot2c_f32_bf16 v201, v162, v191
    v_dot2c_f32_bf16 v202, v163, v190
    v_dot2c_f32_bf16 v203, v163, v191
    v_dot2c_f32_bf16 v204, v164, v190
    v_dot2c_f32_bf16 v205, v164, v191
    v_dot2c_f32_bf16 v206, v165, v190
    v_dot2c_f32_bf16 v207, v165, v191
    v_dot2c_f32_bf16 v208, v166, v190
    v_dot2c_f32_bf16 v209, v166, v191
    v_dot2c_f32_bf16 v210, v167, v190
    v_dot2c_f32_bf16 v211, v167, v191
    v_dot2c_f32_bf16 v212, v168, v190
    v_dot2c_f32_bf16 v213, v168, v191
    v_dot2c_f32_bf16 v214, v169, v190
    v_dot2c_f32_bf16 v215, v169, v191
    v_dot2c_f32_bf16 v216, v170, v190
    v_dot2c_f32_bf16 v217, v170, v191
    v_dot2c_f32_bf16 v218, v171, v190
    v_dot2c_f32_bf16 v219, v171, v191
    s_waitcnt vmcnt(0)
    v_lshrrev_b32 v9, 16, v224
    v_and_b32 v10, 0xffff0000, v224
    v_lshrrev_b32 v190, 16, v188
    v_and_b32 v191, 0xffff0000, v188
    v_dot2c_f32_bf16 v40, v172, v9
    v_dot2c_f32_bf16 v41, v172, v10
    v_dot2c_f32_bf16 v42, v173, v9
    v_dot2c_f32_bf16 v43, v173, v10
    v_dot2c_f32_bf16 v44, v174, v9
    v_dot2c_f32_bf16 v45, v174, v10
    v_dot2c_f32_bf16 v46, v175, v9
    v_dot2c_f32_bf16 v47, v175, v10
    v_dot2c_f32_bf16 v48, v176, v9
    v_dot2c_f32_bf16 v49, v176, v10
    v_dot2c_f32_bf16 v50, v177, v9
    v_dot2c_f32_bf16 v51, v177, v10
    v_dot2c_f32_bf16 v52, v178, v9
    v_dot2c_f32_bf16 v53, v178, v10
    v_dot2c_f32_bf16 v54, v179, v9
    v_dot2c_f32_bf16 v55, v179, v10
    v_dot2c_f32_bf16 v56, v180, v9
    v_dot2c_f32_bf16 v57, v180, v10
    v_dot2c_f32_bf16 v58, v181, v9
    v_dot2c_f32_bf16 v59, v181, v10
    v_dot2c_f32_bf16 v60, v182, v9
    v_dot2c_f32_bf16 v61, v182, v10
    v_dot2c_f32_bf16 v62, v183, v9
    v_dot2c_f32_bf16 v63, v183, v10
    v_dot2c_f32_bf16 v196, v172, v190
    v_dot2c_f32_bf16 v197, v172, v191
    v_dot2c_f32_bf16 v198, v173, v190
    v_dot2c_f32_bf16 v199, v173, v191
    v_dot2c_f32_bf16 v200, v174, v190
    v_dot2c_f32_bf16 v201, v174, v191
    v_dot2c_f32_bf16 v202, v175, v190
    v_dot2c_f32_bf16 v203, v175, v191
    v_dot2c_f32_bf16 v204, v176, v190
    v_dot2c_f32_bf16 v205, v176, v191
    v_dot2c_f32_bf16 v206, v177, v190
    v_dot2c_f32_bf16 v207, v177, v191
    v_dot2c_f32_bf16 v208, v178, v190
    v_dot2c_f32_bf16 v209, v178, v191
    v_dot2c_f32_bf16 v210, v179, v190
    v_dot2c_f32_bf16 v211, v179, v191
    v_dot2c_f32_bf16 v212, v180, v190
    v_dot2c_f32_bf16 v213, v180, v191
    v_dot2c_f32_bf16 v214, v181, v190
    v_dot2c_f32_bf16 v215, v181, v191
    v_dot2c_f32_bf16 v216, v182, v190
    v_dot2c_f32_bf16 v217, v182, v191
    v_dot2c_f32_bf16 v218, v183, v190
    v_dot2c_f32_bf16 v219, v183, v191
    s_nop 2
    v_permlane32_swap_b32 v40, v44
    v_permlane32_swap_b32 v41, v45
    v_permlane32_swap_b32 v42, v46
    v_permlane32_swap_b32 v43, v47
    v_permlane32_swap_b32 v48, v52
    v_permlane32_swap_b32 v49, v53
    v_permlane32_swap_b32 v50, v54
    v_permlane32_swap_b32 v51, v55
    v_permlane32_swap_b32 v56, v60
    v_permlane32_swap_b32 v57, v61
    v_permlane32_swap_b32 v58, v62
    v_permlane32_swap_b32 v59, v63
    v_add_f32 v40, v40, v44
    v_add_f32 v41, v41, v45
    v_add_f32 v42, v42, v46
    v_add_f32 v43, v43, v47
    v_add_f32 v48, v48, v52
    v_add_f32 v49, v49, v53
    v_add_f32 v50, v50, v54
    v_add_f32 v51, v51, v55
    v_add_f32 v56, v56, v60
    v_add_f32 v57, v57, v61
    v_add_f32 v58, v58, v62
    v_add_f32 v59, v59, v63
    s_nop 1
    v_permlane16_swap_b32 v40, v42
    v_permlane16_swap_b32 v41, v43
    v_permlane16_swap_b32 v48, v50
    v_permlane16_swap_b32 v49, v51
    v_permlane16_swap_b32 v56, v58
    v_permlane16_swap_b32 v57, v59
    v_add_f32 v40, v40, v42
    v_add_f32 v41, v41, v43
    v_add_f32 v48, v48, v50
    v_add_f32 v49, v49, v51
    v_add_f32 v56, v56, v58
    v_add_f32 v57, v57, v59
    s_nop 1
    v_add_f32_dpp v40, v40, v40 row_ror:8 row_mask:0xf bank_mask:0x3
    v_add_f32_dpp v48, v48, v48 row_ror:8 row_mask:0xf bank_mask:0x3
    v_add_f32_dpp v56, v56, v56 row_ror:8 row_mask:0xf bank_mask:0x3
    v_add_f32_dpp v40, v41, v41 row_ror:8 row_mask:0xf bank_mask:0xc
    v_add_f32_dpp v48, v49, v49 row_ror:8 row_mask:0xf bank_mask:0xc
    v_add_f32_dpp v56, v57, v57 row_ror:8 row_mask:0xf bank_mask:0xc
    s_nop 2
    v_permlane32_swap_b32 v196, v200
    v_permlane32_swap_b32 v197, v201
    v_permlane32_swap_b32 v198, v202
    v_permlane32_swap_b32 v199, v203
    v_permlane32_swap_b32 v204, v208
    v_permlane32_swap_b32 v205, v209
    v_permlane32_swap_b32 v206, v210
    v_permlane32_swap_b32 v207, v211
    v_permlane32_swap_b32 v212, v216
    v_permlane32_swap_b32 v213, v217
    v_permlane32_swap_b32 v214, v218
    v_permlane32_swap_b32 v215, v219
    v_add_f32 v196, v196, v200
    v_add_f32 v197, v197, v201
    v_add_f32 v198, v198, v202
    v_add_f32 v199, v199, v203
    v_add_f32 v204, v204, v208
    v_add_f32 v205, v205, v209
    v_add_f32 v206, v206, v210
    v_add_f32 v207, v207, v211
    v_add_f32 v212, v212, v216
    v_add_f32 v213, v213, v217
    v_add_f32 v214, v214, v218
    v_add_f32 v215, v215, v219
    s_nop 1
    v_permlane16_swap_b32 v196, v198
    v_permlane16_swap_b32 v197, v199
    v_permlane16_swap_b32 v204, v206
    v_permlane16_swap_b32 v205, v207
    v_permlane16_swap_b32 v212, v214
    v_permlane16_swap_b32 v213, v215
    v_add_f32 v196, v196, v198
    v_add_f32 v197, v197, v199
    v_add_f32 v204, v204, v206
    v_add_f32 v205, v205, v207
    v_add_f32 v212, v212, v214
    v_add_f32 v213, v213, v215
    s_nop 1
    v_add_f32_dpp v196, v196, v196 row_ror:8 row_mask:0xf bank_mask:0x3
    v_add_f32_dpp v204, v204, v204 row_ror:8 row_mask:0xf bank_mask:0x3
    v_add_f32_dpp v212, v212, v212 row_ror:8 row_mask:0xf bank_mask:0x3
    v_add_f32_dpp v196, v197, v197 row_ror:8 row_mask:0xf bank_mask:0xc
    v_add_f32_dpp v204, v205, v205 row_ror:8 row_mask:0xf bank_mask:0xc
    v_add_f32_dpp v212, v213, v213 row_ror:8 row_mask:0xf bank_mask:0xc
    v_readfirstlane_b32 s3, v232
    s_nop 3
    s_add_u32 s48, s3, 1
    v_mov_b32 v12, v40
    v_mov_b32 v16, v196
    v_mov_b32 v13, v48
    v_mov_b32 v17, v204
    v_mov_b32 v14, v56
    v_mov_b32 v18, v212
    v_mov_b32 v15, s48
    v_mov_b32 v19, s48
    v_lshlrev_b32 v10, 4, v1
    s_lshl_b32 s82, s78, 14
    s_add_u32 s82, s82, 3145728
    s_lshl_b32 s83, s79, 10
    s_add_u32 s83, s83, s82
    s_add_u32 s84, s83, 8192
    buffer_store_dwordx4 v[12:15], v10, s[40:43], s83 offen sc1
    buffer_store_dwordx4 v[16:19], v10, s[40:43], s84 offen sc1
    s_lshl_b32 s83, s80, 13
    s_add_u32 s82, s82, s83
    s_add_u32 s83, s82, 4096
    s_mov_b64 s[68:69], -1
    s_mov_b64 s[70:71], -1
    s_mov_b64 s[72:73], -1
    s_mov_b64 s[74:75], -1
    s_mov_b64 s[76:77], -1
    s_mov_b64 s[84:85], -1
    s_mov_b64 s[86:87], -1
    s_mov_b64 s[88:89], -1
    s_mov_b32 s95, 0
    s_sleep 32
L_qpoll:
    s_mov_b64 exec, s[68:69]
    s_cbranch_execz L_qs0
    buffer_load_dwordx4 v[64:67], v10, s[40:43], s82 offen offset:0 sc1
L_qs0:
    s_mov_b64 exec, s[70:71]
    s_cbranch_execz L_qs1
    buffer_load_dwordx4 v[68:71], v10, s[40:43], s82 offen offset:1024 sc1
L_qs1:
    s_mov_b64 exec, s[72:73]
    s_cbranch_execz L_qs2
    buffer_load_dwordx4 v[72:75], v10, s[40:43], s82 offen offset:2048 sc1
L_qs2:
    s_mov_b64 exec, s[74:75]
    s_cbranch_execz L_qs3
    buffer_load_dwordx4 v[76:79], v10, s[40:43], s82 offen offset:3072 sc1
L_qs3:
    s_mov_b64 exec, s[76:77]
    s_cbranch_execz L_qs4
    buffer_load_dwordx4 v[80:83], v10, s[40:43], s83 offen offset:0 sc1
L_qs4:
    s_mov_b64 exec, s[84:85]
    s_cbranch_execz L_qs5
    buffer_load_dwordx4 v[84:87], v10, s[40:43], s83 offen offset:1024 sc1
L_qs5:
    s_mov_b64 exec, s[86:87]
    s_cbranch_execz L_qs6
    buffer_load_dwordx4 v[88:91], v10, s[40:43], s83 offen offset:2048 sc1
L_qs6:
    s_mov_b64 exec, s[88:89]
    s_cbranch_execz L_qs7
    buffer_load_dwordx4 v[92:95], v10, s[40:43], s83 offen offset:3072 sc1
L_qs7:
    s_mov_b64 exec, -1
    s_waitcnt vmcnt(0)
    v_cmp_ne_u32 s[68:69], s48, v67
    v_cmp_ne_u32 s[70:71], s48, v71
    v_cmp_ne_u32 s[72:73], s48, v75
    v_cmp_ne_u32 s[74:75], s48, v79
    v_cmp_ne_u32 s[76:77], s48, v83
    v_cmp_ne_u32 s[84:85], s48, v87
    v_cmp_ne_u32 s[86:87], s48, v91
    v_cmp_ne_u32 s[88:89], s48, v95
    s_nop 4
    s_lshr_b64 vcc, s[68:69], 1
    s_or_b64 s[68:69], s[68:69], vcc
    s_lshr_b64 vcc, s[68:69], 2
    s_or_b64 s[68:69], s[68:69], vcc
    s_and_b32 s68, s68, 0x11111111
    s_and_b32 s69, s69, 0x11111111
    s_mul_i32 s68, s68, 15
    s_mul_i32 s69, s69, 15
    s_or_b32 vcc_lo, s68, s69
    s_lshr_b64 vcc, s[70:71], 1
    s_or_b64 s[70:71], s[70:71], vcc
    s_lshr_b64 vcc, s[70:71], 2
    s_or_b64 s[70:71], s[70:71], vcc
    s_and_b32 s70, s70, 0x11111111
    s_and_b32 s71, s71, 0x11111111
    s_mul_i32 s70, s70, 15
    s_mul_i32 s71, s71, 15
    s_or_b32 vcc_lo, s70, s71
    s_lshr_b64 vcc, s[72:73], 1
    s_or_b64 s[72:73], s[72:73], vcc
    s_lshr_b64 vcc, s[72:73], 2
    s_or_b64 s[72:73], s[72:73], vcc
    s_and_b32 s72, s72, 0x11111111
    s_and_b32 s73, s73, 0x11111111
    s_mul_i32 s72, s72, 15
    s_mul_i32 s73, s73, 15
    s_or_b32 vcc_lo, s72, s73
    s_lshr_b64 vcc, s[74:75], 1
    s_or_b64 s[74:75], s[74:75], vcc
    s_lshr_b64 vcc, s[74:75], 2
    s_or_b64 s[74:75], s[74:75], vcc
    s_and_b32 s74, s74, 0x11111111
    s_and_b32 s75, s75, 0x11111111
    s_mul_i32 s74, s74, 15
    s_mul_i32 s75, s75, 15
    s_or_b32 vcc_lo, s74, s75
    s_lshr_b64 vcc, s[76:77], 1
    s_or_b64 s[76:77], s[76:77], vcc
    s_lshr_b64 vcc, s[76:77], 2
    s_or_b64 s[76:77], s[76:77], vcc
    s_and_b32 s76, s76, 0x11111111
    s_and_b32 s77, s77, 0x11111111
    s_mul_i32 s76, s76, 15
    s_mul_i32 s77, s77, 15
    s_or_b32 vcc_lo, s76, s77
    s_lshr_b64 vcc, s[84:85], 1
    s_or_b64 s[84:85], s[84:85], vcc
    s_lshr_b64 vcc, s[84:85], 2
    s_or_b64 s[84:85], s[84:85], vcc
    s_and_b32 s84, s84, 0x11111111
    s_and_b32 s85, s85, 0x11111111
    s_mul_i32 s84, s84, 15
    s_mul_i32 s85, s85, 15
    s_or_b32 vcc_lo, s84, s85
    s_lshr_b64 vcc, s[86:87], 1
    s_or_b64 s[86:87], s[86:87], vcc
    s_lshr_b64 vcc, s[86:87], 2
    s_or_b64 s[86:87], s[86:87], vcc
    s_and_b32 s86, s86, 0x11111111
    s_and_b32 s87, s87, 0x11111111
    s_mul_i32 s86, s86, 15
    s_mul_i32 s87, s87, 15
    s_or_b32 vcc_lo, s86, s87
    s_lshr_b64 vcc, s[88:89], 1
    s_or_b64 s[88:89], s[88:89], vcc
    s_lshr_b64 vcc, s[88:89], 2
    s_or_b64 s[88:89], s[88:89], vcc
    s_and_b32 s88, s88, 0x11111111
    s_and_b32 s89, s89, 0x11111111
    s_mul_i32 s88, s88, 15
    s_mul_i32 s89, s89, 15
    s_or_b32 vcc_lo, s88, s89
    s_or_b64 vcc, s[68:69], s[70:71]
    s_or_b64 vcc, vcc, s[72:73]
    s_or_b64 vcc, vcc, s[74:75]
    s_or_b64 vcc, vcc, s[76:77]
    s_or_b64 vcc, vcc, s[84:85]
    s_or_b64 vcc, vcc, s[86:87]
    s_or_b64 vcc, vcc, s[88:89]
    s_cbranch_scc0 L_qok
    s_add_u32 s95, s95, 1
    s_cmp_gt_u32 s95, 131072
    s_cbranch_scc1 L_qok
    s_sleep 8
    s_branch L_qpoll
L_qok:
    v_add_f32 v64, v64, v68
    v_add_f32 v72, v72, v76
    v_add_f32 v80, v80, v84
    v_add_f32 v88, v88, v92
    v_add_f32 v65, v65, v69
    v_add_f32 v73, v73, v77
    v_add_f32 v81, v81, v85
    v_add_f32 v89, v89, v93
    v_add_f32 v66, v66, v70
    v_add_f32 v74, v74, v78
    v_add_f32 v82, v82, v86
    v_add_f32 v90, v90, v94
    v_add_f32 v64, v64, v72
    v_add_f32 v80, v80, v88
    v_add_f32 v65, v65, v73
    v_add_f32 v81, v81, v89
    v_add_f32 v66, v66, v74
    v_add_f32 v82, v82, v90
    v_add_f32 v64, v64, v80
    v_add_f32 v65, v65, v81
    v_add_f32 v66, v66, v82
    v_cvt_pk_bf16_f32 v64, v64, v64
    v_cvt_pk_bf16_f32 v65, v65, v65
    v_cvt_pk_bf16_f32 v66, v66, v66
    v_and_b32 v9, 7, v1
    v_lshlrev_b32 v9, 4, v9
    v_lshrrev_b32 v11, 3, v1
    v_lshl_add_u32 v9, v11, 1, v9
    ds_write_b16 v9, v64 offset:40960
    ds_write_b16 v9, v65 offset:41088
    ds_write_b16 v9, v66 offset:41216
    v_mov_b32 v9, 0
    v_mov_b32 v10, s48
    v_mov_b32 v11, 1
    s_mov_b64 exec, 1
    ds_write_b32 v9, v10 offset:42112
    s_waitcnt lgkmcnt(0)
    ds_write_b32 v9, v11 offset:42048
    s_mov_b64 exec, -1
    buffer_load_dwordx4 v[64:67], v2, s[20:23], s52 offen offset:0 nt
    buffer_load_dwordx4 v[68:71], v2, s[20:23], s52 offen offset:128 nt
    buffer_load_dwordx4 v[72:75], v2, s[20:23], s52 offen offset:256 nt
    s_branch L_mainB
L_main:
    buffer_load_dwordx4 v[64:67], v2, s[20:23], s52 offen offset:0 nt
    buffer_load_dwordx4 v[68:71], v2, s[20:23], s52 offen offset:128 nt
    buffer_load_dwordx4 v[72:75], v2, s[20:23], s52 offen offset:256 nt
    s_add_u32 s24, s8, s82
    s_addc_u32 s25, s9, 0
    s_mov_b32 s26, 1572864
    s_mov_b32 s27, 0x00020000
    s_add_u32 s36, s12, s84
    s_addc_u32 s37, s13, 0
    s_mov_b32 s38, 60800
    s_mov_b32 s39, 0x00020000
    s_mov_b32 s44, s14
    s_mov_b32 s45, s15
    s_mov_b32 s46, 2560
    s_mov_b32 s47, 0x00020000
    s_mov_b32 s40, s18
    s_mov_b32 s41, s19
    s_mov_b32 s42, 1610612736
    s_mov_b32 s43, 0x00020000
    s_barrier
    s_cmp_lt_u32 s81, 4
    s_cbranch_scc0 L_mainB
    buffer_load_dwordx4 v[76:79], v2, s[20:23], s53 offen offset:0 nt
    buffer_load_dwordx4 v[80:83], v2, s[20:23], s53 offen offset:128 nt
    s_waitcnt vmcnt(4)
    buffer_load_dwordx4 v[84:87], v2, s[20:23], s53 offen offset:256 nt
    s_waitcnt vmcnt(4)
    buffer_load_dwordx4 v[88:91], v2, s[20:23], s54 offen offset:0 nt
    s_waitcnt vmcnt(4)
    buffer_load_dwordx4 v[92:95], v2, s[20:23], s54 offen offset:128 nt
    s_waitcnt vmcnt(4)
    buffer_load_dwordx4 v[96:99], v2, s[20:23], s54 offen offset:256 nt
    s_waitcnt vmcnt(4)
    buffer_load_dwordx4 v[100:103], v2, s[20:23], s55 offen offset:0 nt
    s_waitcnt vmcnt(4)
    buffer_load_dwordx4 v[104:107], v2, s[20:23], s55 offen offset:128 nt
    s_waitcnt vmcnt(4)
    buffer_load_dwordx4 v[108:111], v2, s[20:23], s55 offen offset:256 nt
    s_waitcnt vmcnt(4)
    buffer_load_dwordx4 v[112:115], v2, s[20:23], s56 offen offset:0 nt
    s_waitcnt vmcnt(4)
    buffer_load_dwordx4 v[116:119], v2, s[20:23], s56 offen offset:128 nt
    s_waitcnt vmcnt(4)
    buffer_load_dwordx4 v[120:123], v2, s[20:23], s56 offen offset:256 nt
    s_waitcnt vmcnt(4)
    buffer_load_dwordx4 v[124:127], v2, s[20:23], s57 offen offset:0 nt
    s_waitcnt vmcnt(4)
    buffer_load_dwordx4 v[128:131], v2, s[20:23], s57 offen offset:128 nt
    s_waitcnt vmcnt(4)
    buffer_load_dwordx4 v[132:135], v2, s[20:23], s57 offen offset:256 nt
    s_waitcnt vmcnt(4)
    buffer_load_dwordx4 v[136:139], v2, s[20:23], s58 offen offset:0 nt
    s_waitcnt vmcnt(4)
    buffer_load_dwordx4 v[140:143], v2, s[20:23], s58 offen offset:128 nt
    s_waitcnt vmcnt(4)
    buffer_load_dwordx4 v[144:147], v2, s[20:23], s58 offen offset:256 nt
    s_waitcnt vmcnt(4)
    buffer_load_dwordx4 v[148:151], v2, s[20:23], s59 offen offset:0 nt
    s_waitcnt vmcnt(4)
    buffer_load_dwordx4 v[152:155], v2, s[20:23], s59 offen offset:128 nt
    s_waitcnt vmcnt(4)
    buffer_load_dwordx4 v[156:159], v2, s[20:23], s59 offen offset:256 nt
    s_waitcnt vmcnt(4)
    buffer_load_dwordx4 v[160:163], v2, s[20:23], s60 offen offset:0 nt
    s_waitcnt vmcnt(4)
    buffer_load_dwordx4 v[164:167], v2, s[20:23], s60 offen offset:128 nt
    s_waitcnt vmcnt(4)
    buffer_load_dwordx4 v[168:171], v2, s[20:23], s60 offen offset:256 nt
    buffer_load_dwordx4 v[172:175], v2, s[20:23], s61 offen offset:0 nt
    buffer_load_dwordx4 v[176:179], v2, s[20:23], s61 offen offset:128 nt
    buffer_load_dwordx4 v[180:183], v2, s[20:23], s61 offen offset:256 nt
    buffer_load_dwordx4 v[184:187], v2, s[20:23], s62 offen offset:0 nt
    buffer_load_dwordx4 v[188:191], v2, s[20:23], s62 offen offset:128 nt
    buffer_load_dwordx4 v[192:195], v2, s[20:23], s62 offen offset:256 nt
    buffer_load_dwordx4 v[196:199], v2, s[20:23], s63 offen offset:0 nt
    buffer_load_dwordx4 v[200:203], v2, s[20:23], s63 offen offset:128 nt
    buffer_load_dwordx4 v[204:207], v2, s[20:23], s63 offen offset:256 nt
    buffer_load_dwordx4 v[208:211], v2, s[20:23], s64 offen offset:0 nt
    buffer_load_dwordx4 v[212:215], v2, s[20:23], s64 offen offset:128 nt
    buffer_load_dwordx4 v[216:219], v2, s[20:23], s64 offen offset:256 nt
    buffer_load_dwordx4 v[220:223], v2, s[20:23], s65 offen offset:0 nt
    buffer_load_dwordx4 v[224:227], v2, s[20:23], s65 offen offset:128 nt
    buffer_load_dwordx4 v[228:231], v2, s[20:23], s65 offen offset:256 nt
    buffer_load_dwordx4 v[232:235], v2, s[20:23], s66 offen offset:0 nt
    buffer_load_dwordx4 v[236:239], v2, s[20:23], s66 offen offset:128 nt
    buffer_load_dwordx4 v[240:243], v2, s[20:23], s66 offen offset:256 nt
    buffer_load_dwordx4 v[244:247], v2, s[20:23], s67 offen offset:0 nt
    buffer_load_dwordx4 v[248:251], v2, s[20:23], s67 offen offset:128 nt
    buffer_load_dwordx4 v[252:255], v2, s[20:23], s67 offen offset:256 nt
    v_and_b32 v9, 7, v1
    v_lshlrev_b32 v10, 5, v9
    v_lshrrev_b32 v11, 3, v1
    v_lshl_add_u32 v10, v11, 2, v10
    s_lshl_b32 s82, s81, 10
    v_add_u32 v5, s82, v10
    v_mov_b32 v24, 0
    v_mov_b32 v25, 0
    v_mov_b32 v26, 0
    v_mov_b32 v27, 0
    v_mov_b32 v28, 0
    v_mov_b32 v29, 0
    v_mov_b32 v30, 0
    v_mov_b32 v31, 0
    v_mov_b32 v32, 0
    v_mov_b32 v33, 0
    v_mov_b32 v34, 0
    v_mov_b32 v35, 0
    v_mov_b32 v36, 0
    v_mov_b32 v37, 0
    v_mov_b32 v38, 0
    v_mov_b32 v39, 0
    v_mov_b32 v11, 0
    s_mov_b32 s95, 0
L_qwaitA:
    ds_read_b32 v10, v11 offset:42048
    s_waitcnt lgkmcnt(0)
    v_cmp_ne_u32 vcc, 1, v10
    s_nop 4
    s_cmp_eq_u64 vcc, 0
    s_cbranch_scc1 L_qreadyA
    s_add_u32 s95, s95, 1
    s_cmp_gt_u32 s95, 2097152
    s_cbranch_scc1 L_qreadyA
    s_sleep 4
    s_branch L_qwaitA
L_qreadyA:
    v_lshlrev_b32 v9, 4, v9
    ds_read_b128 v[12:15], v9 offset:40960
    ds_read_b128 v[16:19], v9 offset:41088
    ds_read_b128 v[20:23], v9 offset:41216
    ds_read_b32 v3, v11 offset:42112
    v_mov_b32 v4, 0xff
    s_waitcnt lgkmcnt(0)
    v_readfirstlane_b32 s48, v3
    v_and_b32 v3, 0xff, v3
    s_waitcnt lgkmcnt(0)
    v_dot2c_f32_bf16 v24, v64, v12
    v_dot2c_f32_bf16 v24, v65, v13
    v_dot2c_f32_bf16 v24, v66, v14
    v_dot2c_f32_bf16 v24, v67, v15
    v_dot2c_f32_bf16 v24, v68, v16
    v_dot2c_f32_bf16 v24, v69, v17
    v_dot2c_f32_bf16 v24, v70, v18
    v_dot2c_f32_bf16 v24, v71, v19
    v_dot2c_f32_bf16 v24, v72, v20
    v_dot2c_f32_bf16 v24, v73, v21
    v_dot2c_f32_bf16 v24, v74, v22
    v_dot2c_f32_bf16 v24, v75, v23
    buffer_load_dwordx4 v[64:67], v2, s[24:27], s52 offen offset:0 nt
    buffer_load_dwordx4 v[68:71], v2, s[24:27], s52 offen offset:128 nt
    buffer_load_dwordx4 v[72:75], v2, s[24:27], s52 offen offset:256 nt
    v_dot2c_f32_bf16 v25, v76, v12
    v_dot2c_f32_bf16 v25, v77, v13
    v_dot2c_f32_bf16 v25, v78, v14
    v_dot2c_f32_bf16 v25, v79, v15
    v_dot2c_f32_bf16 v25, v80, v16
    v_dot2c_f32_bf16 v25, v81, v17
    v_dot2c_f32_bf16 v25, v82, v18
    v_dot2c_f32_bf16 v25, v83, v19
    v_dot2c_f32_bf16 v25, v84, v20
    v_dot2c_f32_bf16 v25, v85, v21
    v_dot2c_f32_bf16 v25, v86, v22
    v_dot2c_f32_bf16 v25, v87, v23
    buffer_load_dwordx4 v[76:79], v2, s[24:27], s53 offen offset:0 nt
    buffer_load_dwordx4 v[80:83], v2, s[24:27], s53 offen offset:128 nt
    buffer_load_dwordx4 v[84:87], v2, s[24:27], s53 offen offset:256 nt
    v_dot2c_f32_bf16 v26, v88, v12
    v_dot2c_f32_bf16 v26, v89, v13
    v_dot2c_f32_bf16 v26, v90, v14
    v_dot2c_f32_bf16 v26, v91, v15
    v_dot2c_f32_bf16 v26, v92, v16
    v_dot2c_f32_bf16 v26, v93, v17
    v_dot2c_f32_bf16 v26, v94, v18
    v_dot2c_f32_bf16 v26, v95, v19
    v_dot2c_f32_bf16 v26, v96, v20
    v_dot2c_f32_bf16 v26, v97, v21
    v_dot2c_f32_bf16 v26, v98, v22
    v_dot2c_f32_bf16 v26, v99, v23
    buffer_load_dwordx4 v[88:91], v2, s[24:27], s54 offen offset:0 nt
    buffer_load_dwordx4 v[92:95], v2, s[24:27], s54 offen offset:128 nt
    buffer_load_dwordx4 v[96:99], v2, s[24:27], s54 offen offset:256 nt
    v_dot2c_f32_bf16 v27, v100, v12
    v_dot2c_f32_bf16 v27, v101, v13
    v_dot2c_f32_bf16 v27, v102, v14
    v_dot2c_f32_bf16 v27, v103, v15
    v_dot2c_f32_bf16 v27, v104, v16
    v_dot2c_f32_bf16 v27, v105, v17
    v_dot2c_f32_bf16 v27, v106, v18
    v_dot2c_f32_bf16 v27, v107, v19
    v_dot2c_f32_bf16 v27, v108, v20
    v_dot2c_f32_bf16 v27, v109, v21
    v_dot2c_f32_bf16 v27, v110, v22
    v_dot2c_f32_bf16 v27, v111, v23
    buffer_load_dwordx4 v[100:103], v2, s[24:27], s55 offen offset:0 nt
    buffer_load_dwordx4 v[104:107], v2, s[24:27], s55 offen offset:128 nt
    buffer_load_dwordx4 v[108:111], v2, s[24:27], s55 offen offset:256 nt
    v_dot2c_f32_bf16 v28, v112, v12
    v_dot2c_f32_bf16 v28, v113, v13
    v_dot2c_f32_bf16 v28, v114, v14
    v_dot2c_f32_bf16 v28, v115, v15
    v_dot2c_f32_bf16 v28, v116, v16
    v_dot2c_f32_bf16 v28, v117, v17
    v_dot2c_f32_bf16 v28, v118, v18
    v_dot2c_f32_bf16 v28, v119, v19
    v_dot2c_f32_bf16 v28, v120, v20
    v_dot2c_f32_bf16 v28, v121, v21
    v_dot2c_f32_bf16 v28, v122, v22
    v_dot2c_f32_bf16 v28, v123, v23
    buffer_load_dwordx4 v[112:115], v2, s[24:27], s56 offen offset:0 nt
    buffer_load_dwordx4 v[116:119], v2, s[24:27], s56 offen offset:128 nt
    buffer_load_dwordx4 v[120:123], v2, s[24:27], s56 offen offset:256 nt
    v_dot2c_f32_bf16 v29, v124, v12
    v_dot2c_f32_bf16 v29, v125, v13
    v_dot2c_f32_bf16 v29, v126, v14
    v_dot2c_f32_bf16 v29, v127, v15
    v_dot2c_f32_bf16 v29, v128, v16
    v_dot2c_f32_bf16 v29, v129, v17
    v_dot2c_f32_bf16 v29, v130, v18
    v_dot2c_f32_bf16 v29, v131, v19
    v_dot2c_f32_bf16 v29, v132, v20
    v_dot2c_f32_bf16 v29, v133, v21
    v_dot2c_f32_bf16 v29, v134, v22
    v_dot2c_f32_bf16 v29, v135, v23
    buffer_load_dwordx4 v[124:127], v2, s[24:27], s57 offen offset:0 nt
    buffer_load_dwordx4 v[128:131], v2, s[24:27], s57 offen offset:128 nt
    buffer_load_dwordx4 v[132:135], v2, s[24:27], s57 offen offset:256 nt
    v_dot2c_f32_bf16 v30, v136, v12
    v_dot2c_f32_bf16 v30, v137, v13
    v_dot2c_f32_bf16 v30, v138, v14
    v_dot2c_f32_bf16 v30, v139, v15
    v_dot2c_f32_bf16 v30, v140, v16
    v_dot2c_f32_bf16 v30, v141, v17
    v_dot2c_f32_bf16 v30, v142, v18
    v_dot2c_f32_bf16 v30, v143, v19
    v_dot2c_f32_bf16 v30, v144, v20
    v_dot2c_f32_bf16 v30, v145, v21
    v_dot2c_f32_bf16 v30, v146, v22
    v_dot2c_f32_bf16 v30, v147, v23
    buffer_load_dwordx4 v[136:139], v2, s[24:27], s58 offen offset:0 nt
    buffer_load_dwordx4 v[140:143], v2, s[24:27], s58 offen offset:128 nt
    buffer_load_dwordx4 v[144:147], v2, s[24:27], s58 offen offset:256 nt
    s_waitcnt vmcnt(45)
    v_dot2c_f32_bf16 v31, v148, v12
    v_dot2c_f32_bf16 v31, v149, v13
    v_dot2c_f32_bf16 v31, v150, v14
    v_dot2c_f32_bf16 v31, v151, v15
    v_dot2c_f32_bf16 v31, v152, v16
    v_dot2c_f32_bf16 v31, v153, v17
    v_dot2c_f32_bf16 v31, v154, v18
    v_dot2c_f32_bf16 v31, v155, v19
    v_dot2c_f32_bf16 v31, v156, v20
    v_dot2c_f32_bf16 v31, v157, v21
    v_dot2c_f32_bf16 v31, v158, v22
    v_dot2c_f32_bf16 v31, v159, v23
    buffer_load_dwordx4 v[148:151], v2, s[24:27], s59 offen offset:0 nt
    buffer_load_dwordx4 v[152:155], v2, s[24:27], s59 offen offset:128 nt
    buffer_load_dwordx4 v[156:159], v2, s[24:27], s59 offen offset:256 nt
    s_waitcnt vmcnt(45)
    v_dot2c_f32_bf16 v32, v160, v12
    v_dot2c_f32_bf16 v32, v161, v13
    v_dot2c_f32_bf16 v32, v162, v14
    v_dot2c_f32_bf16 v32, v163, v15
    v_dot2c_f32_bf16 v32, v164, v16
    v_dot2c_f32_bf16 v32, v165, v17
    v_dot2c_f32_bf16 v32, v166, v18
    v_dot2c_f32_bf16 v32, v167, v19
    v_dot2c_f32_bf16 v32, v168, v20
    v_dot2c_f32_bf16 v32, v169, v21
    v_dot2c_f32_bf16 v32, v170, v22
    v_dot2c_f32_bf16 v32, v171, v23
    buffer_load_dwordx4 v[160:163], v2, s[24:27], s60 offen offset:0 nt
    buffer_load_dwordx4 v[164:167], v2, s[24:27], s60 offen offset:128 nt
    buffer_load_dwordx4 v[168:171], v2, s[24:27], s60 offen offset:256 nt
    s_waitcnt vmcnt(45)
    v_dot2c_f32_bf16 v33, v172, v12
    v_dot2c_f32_bf16 v33, v173, v13
    v_dot2c_f32_bf16 v33, v174, v14
    v_dot2c_f32_bf16 v33, v175, v15
    v_dot2c_f32_bf16 v33, v176, v16
    v_dot2c_f32_bf16 v33, v177, v17
    v_dot2c_f32_bf16 v33, v178, v18
    v_dot2c_f32_bf16 v33, v179, v19
    v_dot2c_f32_bf16 v33, v180, v20
    v_dot2c_f32_bf16 v33, v181, v21
    v_dot2c_f32_bf16 v33, v182, v22
    v_dot2c_f32_bf16 v33, v183, v23
    buffer_load_dwordx4 v[172:175], v2, s[24:27], s61 offen offset:0 nt
    buffer_load_dwordx4 v[176:179], v2, s[24:27], s61 offen offset:128 nt
    buffer_load_dwordx4 v[180:183], v2, s[24:27], s61 offen offset:256 nt
    s_waitcnt vmcnt(45)
    v_dot2c_f32_bf16 v34, v184, v12
    v_dot2c_f32_bf16 v34, v185, v13
    v_dot2c_f32_bf16 v34, v186, v14
    v_dot2c_f32_bf16 v34, v187, v15
    v_dot2c_f32_bf16 v34, v188, v16
    v_dot2c_f32_bf16 v34, v189, v17
    v_dot2c_f32_bf16 v34, v190, v18
    v_dot2c_f32_bf16 v34, v191, v19
    v_dot2c_f32_bf16 v34, v192, v20
    v_dot2c_f32_bf16 v34, v193, v21
    v_dot2c_f32_bf16 v34, v194, v22
    v_dot2c_f32_bf16 v34, v195, v23
    buffer_load_dwordx4 v[184:187], v2, s[24:27], s62 offen offset:0 nt
    buffer_load_dwordx4 v[188:191], v2, s[24:27], s62 offen offset:128 nt
    buffer_load_dwordx4 v[192:195], v2, s[24:27], s62 offen offset:256 nt
    s_waitcnt vmcnt(45)
    v_dot2c_f32_bf16 v35, v196, v12
    v_dot2c_f32_bf16 v35, v197, v13
    v_dot2c_f32_bf16 v35, v198, v14
    v_dot2c_f32_bf16 v35, v199, v15
    v_dot2c_f32_bf16 v35, v200, v16
    v_dot2c_f32_bf16 v35, v201, v17
    v_dot2c_f32_bf16 v35, v202, v18
    v_dot2c_f32_bf16 v35, v203, v19
    v_dot2c_f32_bf16 v35, v204, v20
    v_dot2c_f32_bf16 v35, v205, v21
    v_dot2c_f32_bf16 v35, v206, v22
    v_dot2c_f32_bf16 v35, v207, v23
    buffer_load_dwordx4 v[196:199], v2, s[24:27], s63 offen offset:0 nt
    buffer_load_dwordx4 v[200:203], v2, s[24:27], s63 offen offset:128 nt
    buffer_load_dwordx4 v[204:207], v2, s[24:27], s63 offen offset:256 nt
    s_waitcnt vmcnt(45)
    v_dot2c_f32_bf16 v36, v208, v12
    v_dot2c_f32_bf16 v36, v209, v13
    v_dot2c_f32_bf16 v36, v210, v14
    v_dot2c_f32_bf16 v36, v211, v15
    v_dot2c_f32_bf16 v36, v212, v16
    v_dot2c_f32_bf16 v36, v213, v17
    v_dot2c_f32_bf16 v36, v214, v18
    v_dot2c_f32_bf16 v36, v215, v19
    v_dot2c_f32_bf16 v36, v216, v20
    v_dot2c_f32_bf16 v36, v217, v21
    v_dot2c_f32_bf16 v36, v218, v22
    v_dot2c_f32_bf16 v36, v219, v23
    buffer_load_dwordx4 v[208:211], v2, s[24:27], s64 offen offset:0 nt
    buffer_load_dwordx4 v[212:215], v2, s[24:27], s64 offen offset:128 nt
    buffer_load_dwordx4 v[216:219], v2, s[24:27], s64 offen offset:256 nt
    s_waitcnt vmcnt(45)
    v_dot2c_f32_bf16 v37, v220, v12
    v_dot2c_f32_bf16 v37, v221, v13
    v_dot2c_f32_bf16 v37, v222, v14
    v_dot2c_f32_bf16 v37, v223, v15
    v_dot2c_f32_bf16 v37, v224, v16
    v_dot2c_f32_bf16 v37, v225, v17
    v_dot2c_f32_bf16 v37, v226, v18
    v_dot2c_f32_bf16 v37, v227, v19
    v_dot2c_f32_bf16 v37, v228, v20
    v_dot2c_f32_bf16 v37, v229, v21
    v_dot2c_f32_bf16 v37, v230, v22
    v_dot2c_f32_bf16 v37, v231, v23
    buffer_load_dwordx4 v[220:223], v2, s[24:27], s65 offen offset:0 nt
    buffer_load_dwordx4 v[224:227], v2, s[24:27], s65 offen offset:128 nt
    buffer_load_dwordx4 v[228:231], v2, s[24:27], s65 offen offset:256 nt
    s_waitcnt vmcnt(45)
    v_dot2c_f32_bf16 v38, v232, v12
    v_dot2c_f32_bf16 v38, v233, v13
    v_dot2c_f32_bf16 v38, v234, v14
    v_dot2c_f32_bf16 v38, v235, v15
    v_dot2c_f32_bf16 v38, v236, v16
    v_dot2c_f32_bf16 v38, v237, v17
    v_dot2c_f32_bf16 v38, v238, v18
    v_dot2c_f32_bf16 v38, v239, v19
    v_dot2c_f32_bf16 v38, v240, v20
    v_dot2c_f32_bf16 v38, v241, v21
    v_dot2c_f32_bf16 v38, v242, v22
    v_dot2c_f32_bf16 v38, v243, v23
    buffer_load_dwordx4 v[232:235], v2, s[24:27], s66 offen offset:0 nt
    buffer_load_dwordx4 v[236:239], v2, s[24:27], s66 offen offset:128 nt
    buffer_load_dwordx4 v[240:243], v2, s[24:27], s66 offen offset:256 nt
    s_waitcnt vmcnt(45)
    v_dot2c_f32_bf16 v39, v244, v12
    v_dot2c_f32_bf16 v39, v245, v13
    v_dot2c_f32_bf16 v39, v246, v14
    v_dot2c_f32_bf16 v39, v247, v15
    v_dot2c_f32_bf16 v39, v248, v16
    v_dot2c_f32_bf16 v39, v249, v17
    v_dot2c_f32_bf16 v39, v250, v18
    v_dot2c_f32_bf16 v39, v251, v19
    v_dot2c_f32_bf16 v39, v252, v20
    v_dot2c_f32_bf16 v39, v253, v21
    v_dot2c_f32_bf16 v39, v254, v22
    v_dot2c_f32_bf16 v39, v255, v23
    buffer_load_dwordx4 v[244:247], v2, s[24:27], s67 offen offset:0 nt
    buffer_load_dwordx4 v[248:251], v2, s[24:27], s67 offen offset:128 nt
    buffer_load_dwordx4 v[252:255], v2, s[24:27], s67 offen offset:256 nt
    s_nop 2
    v_add_f32_dpp v24, v24, v24 quad_perm:[1,0,3,2] row_mask:0xf bank_mask:0xf
    v_add_f32_dpp v25, v25, v25 quad_perm:[1,0,3,2] row_mask:0xf bank_mask:0xf
    v_add_f32_dpp v26, v26, v26 quad_perm:[1,0,3,2] row_mask:0xf bank_mask:0xf
    v_add_f32_dpp v27, v27, v27 quad_perm:[1,0,3,2] row_mask:0xf bank_mask:0xf
    v_add_f32_dpp v28, v28, v28 quad_perm:[1,0,3,2] row_mask:0xf bank_mask:0xf
    v_add_f32_dpp v29, v29, v29 quad_perm:[1,0,3,2] row_mask:0xf bank_mask:0xf
    v_add_f32_dpp v30, v30, v30 quad_perm:[1,0,3,2] row_mask:0xf bank_mask:0xf
    v_add_f32_dpp v31, v31, v31 quad_perm:[1,0,3,2] row_mask:0xf bank_mask:0xf
    v_add_f32_dpp v32, v32, v32 quad_perm:[1,0,3,2] row_mask:0xf bank_mask:0xf
    v_add_f32_dpp v33, v33, v33 quad_perm:[1,0,3,2] row_mask:0xf bank_mask:0xf
    v_add_f32_dpp v34, v34, v34 quad_perm:[1,0,3,2] row_mask:0xf bank_mask:0xf
    v_add_f32_dpp v35, v35, v35 quad_perm:[1,0,3,2] row_mask:0xf bank_mask:0xf
    v_add_f32_dpp v36, v36, v36 quad_perm:[1,0,3,2] row_mask:0xf bank_mask:0xf
    v_add_f32_dpp v37, v37, v37 quad_perm:[1,0,3,2] row_mask:0xf bank_mask:0xf
    v_add_f32_dpp v38, v38, v38 quad_perm:[1,0,3,2] row_mask:0xf bank_mask:0xf
    v_add_f32_dpp v39, v39, v39 quad_perm:[1,0,3,2] row_mask:0xf bank_mask:0xf
    v_add_f32_dpp v24, v24, v24 quad_perm:[2,3,0,1] row_mask:0xf bank_mask:0xf
    v_add_f32_dpp v25, v25, v25 quad_perm:[2,3,0,1] row_mask:0xf bank_mask:0xf
    v_add_f32_dpp v26, v26, v26 quad_perm:[2,3,0,1] row_mask:0xf bank_mask:0xf
    v_add_f32_dpp v27, v27, v27 quad_perm:[2,3,0,1] row_mask:0xf bank_mask:0xf
    v_add_f32_dpp v28, v28, v28 quad_perm:[2,3,0,1] row_mask:0xf bank_mask:0xf
    v_add_f32_dpp v29, v29, v29 quad_perm:[2,3,0,1] row_mask:0xf bank_mask:0xf
    v_add_f32_dpp v30, v30, v30 quad_perm:[2,3,0,1] row_mask:0xf bank_mask:0xf
    v_add_f32_dpp v31, v31, v31 quad_perm:[2,3,0,1] row_mask:0xf bank_mask:0xf
    v_add_f32_dpp v32, v32, v32 quad_perm:[2,3,0,1] row_mask:0xf bank_mask:0xf
    v_add_f32_dpp v33, v33, v33 quad_perm:[2,3,0,1] row_mask:0xf bank_mask:0xf
    v_add_f32_dpp v34, v34, v34 quad_perm:[2,3,0,1] row_mask:0xf bank_mask:0xf
    v_add_f32_dpp v35, v35, v35 quad_perm:[2,3,0,1] row_mask:0xf bank_mask:0xf
    v_add_f32_dpp v36, v36, v36 quad_perm:[2,3,0,1] row_mask:0xf bank_mask:0xf
    v_add_f32_dpp v37, v37, v37 quad_perm:[2,3,0,1] row_mask:0xf bank_mask:0xf
    v_add_f32_dpp v38, v38, v38 quad_perm:[2,3,0,1] row_mask:0xf bank_mask:0xf
    v_add_f32_dpp v39, v39, v39 quad_perm:[2,3,0,1] row_mask:0xf bank_mask:0xf
    v_add_f32_dpp v24, v24, v24 row_half_mirror row_mask:0xf bank_mask:0xf
    v_add_f32_dpp v25, v25, v25 row_half_mirror row_mask:0xf bank_mask:0xf
    v_add_f32_dpp v26, v26, v26 row_half_mirror row_mask:0xf bank_mask:0xf
    v_add_f32_dpp v27, v27, v27 row_half_mirror row_mask:0xf bank_mask:0xf
    v_add_f32_dpp v28, v28, v28 row_half_mirror row_mask:0xf bank_mask:0xf
    v_add_f32_dpp v29, v29, v29 row_half_mirror row_mask:0xf bank_mask:0xf
    v_add_f32_dpp v30, v30, v30 row_half_mirror row_mask:0xf bank_mask:0xf
    v_add_f32_dpp v31, v31, v31 row_half_mirror row_mask:0xf bank_mask:0xf
    v_add_f32_dpp v32, v32, v32 row_half_mirror row_mask:0xf bank_mask:0xf
    v_add_f32_dpp v33, v33, v33 row_half_mirror row_mask:0xf bank_mask:0xf
    v_add_f32_dpp v34, v34, v34 row_half_mirror row_mask:0xf bank_mask:0xf
    v_add_f32_dpp v35, v35, v35 row_half_mirror row_mask:0xf bank_mask:0xf
    v_add_f32_dpp v36, v36, v36 row_half_mirror row_mask:0xf bank_mask:0xf
    v_add_f32_dpp v37, v37, v37 row_half_mirror row_mask:0xf bank_mask:0xf
    v_add_f32_dpp v38, v38, v38 row_half_mirror row_mask:0xf bank_mask:0xf
    v_add_f32_dpp v39, v39, v39 row_half_mirror row_mask:0xf bank_mask:0xf
    v_cvt_pk_bf16_f32 v40, v24, v25
    v_cvt_pk_bf16_f32 v41, v26, v27
    v_cvt_pk_bf16_f32 v42, v28, v29
    v_cvt_pk_bf16_f32 v43, v30, v31
    v_cvt_pk_bf16_f32 v44, v32, v33
    v_cvt_pk_bf16_f32 v45, v34, v35
    v_cvt_pk_bf16_f32 v46, v36, v37
    v_cvt_pk_bf16_f32 v47, v38, v39
    v_lshlrev_b32 v24, 16, v40
    v_and_b32 v25, 0xffff0000, v40
    v_lshlrev_b32 v26, 16, v41
    v_and_b32 v27, 0xffff0000, v41
    v_lshlrev_b32 v28, 16, v42
    v_and_b32 v29, 0xffff0000, v42
    v_lshlrev_b32 v30, 16, v43
    v_and_b32 v31, 0xffff0000, v43
    v_lshlrev_b32 v32, 16, v44
    v_and_b32 v33, 0xffff0000, v44
    v_lshlrev_b32 v34, 16, v45
    v_and_b32 v35, 0xffff0000, v45
    v_lshlrev_b32 v36, 16, v46
    v_and_b32 v37, 0xffff0000, v46
    v_lshlrev_b32 v38, 16, v47
    v_and_b32 v39, 0xffff0000, v47
    v_mul_f32 v24, 0x3d93cd3a, v24
    v_mul_f32 v25, 0x3d93cd3a, v25
    v_mul_f32 v26, 0x3d93cd3a, v26
    v_mul_f32 v27, 0x3d93cd3a, v27
    v_mul_f32 v28, 0x3d93cd3a, v28
    v_mul_f32 v29, 0x3d93cd3a, v29
    v_mul_f32 v30, 0x3d93cd3a, v30
    v_mul_f32 v31, 0x3d93cd3a, v31
    v_mul_f32 v32, 0x3d93cd3a, v32
    v_mul_f32 v33, 0x3d93cd3a, v33
    v_mul_f32 v34, 0x3d93cd3a, v34
    v_mul_f32 v35, 0x3d93cd3a, v35
    v_mul_f32 v36, 0x3d93cd3a, v36
    v_mul_f32 v37, 0x3d93cd3a, v37
    v_mul_f32 v38, 0x3d93cd3a, v38
    v_mul_f32 v39, 0x3d93cd3a, v39
    v_cvt_pk_bf16_f32 v40, v24, v25
    v_cvt_pk_bf16_f32 v41, v26, v27
    v_cvt_pk_bf16_f32 v42, v28, v29
    v_cvt_pk_bf16_f32 v43, v30, v31
    v_cvt_pk_bf16_f32 v44, v32, v33
    v_cvt_pk_bf16_f32 v45, v34, v35
    v_cvt_pk_bf16_f32 v46, v36, v37
    v_cvt_pk_bf16_f32 v47, v38, v39
    v_lshlrev_b32 v24, 16, v40
    v_and_b32 v25, 0xffff0000, v40
    v_lshlrev_b32 v26, 16, v41
    v_and_b32 v27, 0xffff0000, v41
    v_lshlrev_b32 v28, 16, v42
    v_and_b32 v29, 0xffff0000, v42
    v_lshlrev_b32 v30, 16, v43
    v_and_b32 v31, 0xffff0000, v43
    v_lshlrev_b32 v32, 16, v44
    v_and_b32 v33, 0xffff0000, v44
    v_lshlrev_b32 v34, 16, v45
    v_and_b32 v35, 0xffff0000, v45
    v_lshlrev_b32 v36, 16, v46
    v_and_b32 v37, 0xffff0000, v46
    v_lshlrev_b32 v38, 16, v47
    v_and_b32 v39, 0xffff0000, v47
    v_max3_f32 v7, v24, v25, v26
    v_max3_f32 v7, v7, v27, v28
    v_max3_f32 v7, v7, v29, v30
    v_max3_f32 v7, v7, v31, v32
    v_max3_f32 v7, v7, v33, v34
    v_max3_f32 v7, v7, v35, v36
    v_max3_f32 v7, v7, v37, v38
    v_max_f32 v7, v7, v39
    s_nop 1
    v_max_f32_dpp v7, v7, v7 row_ror:8 row_mask:0xf bank_mask:0xf
    v_mov_b32 v9, v7
    s_nop 1
    v_permlane16_swap_b32 v7, v9
    v_max_f32 v7, v7, v9
    v_mov_b32 v9, v7
    s_nop 1
    v_permlane32_swap_b32 v7, v9
    v_max_f32 v7, v7, v9
    v_sub_f32 v24, v24, v7
    v_sub_f32 v25, v25, v7
    v_sub_f32 v26, v26, v7
    v_sub_f32 v27, v27, v7
    v_sub_f32 v28, v28, v7
    v_sub_f32 v29, v29, v7
    v_sub_f32 v30, v30, v7
    v_sub_f32 v31, v31, v7
    v_sub_f32 v32, v32, v7
    v_sub_f32 v33, v33, v7
    v_sub_f32 v34, v34, v7
    v_sub_f32 v35, v35, v7
    v_sub_f32 v36, v36, v7
    v_sub_f32 v37, v37, v7
    v_sub_f32 v38, v38, v7
    v_sub_f32 v39, v39, v7
    v_mul_f32 v24, 0x3fb8aa3b, v24
    v_mul_f32 v25, 0x3fb8aa3b, v25
    v_mul_f32 v26, 0x3fb8aa3b, v26
    v_mul_f32 v27, 0x3fb8aa3b, v27
    v_mul_f32 v28, 0x3fb8aa3b, v28
    v_mul_f32 v29, 0x3fb8aa3b, v29
    v_mul_f32 v30, 0x3fb8aa3b, v30
    v_mul_f32 v31, 0x3fb8aa3b, v31
    v_mul_f32 v32, 0x3fb8aa3b, v32
    v_mul_f32 v33, 0x3fb8aa3b, v33
    v_mul_f32 v34, 0x3fb8aa3b, v34
    v_mul_f32 v35, 0x3fb8aa3b, v35
    v_mul_f32 v36, 0x3fb8aa3b, v36
    v_mul_f32 v37, 0x3fb8aa3b, v37
    v_mul_f32 v38, 0x3fb8aa3b, v38
    v_mul_f32 v39, 0x3fb8aa3b, v39
    v_exp_f32 v24, v24
    v_exp_f32 v25, v25
    v_exp_f32 v26, v26
    v_exp_f32 v27, v27
    v_exp_f32 v28, v28
    v_exp_f32 v29, v29
    v_exp_f32 v30, v30
    v_exp_f32 v31, v31
    v_exp_f32 v32, v32
    v_exp_f32 v33, v33
    v_exp_f32 v34, v34
    v_exp_f32 v35, v35
    v_exp_f32 v36, v36
    v_exp_f32 v37, v37
    v_exp_f32 v38, v38
    v_exp_f32 v39, v39
    s_nop 0
    v_add_f32 v6, v24, v25
    v_add_f32 v6, v6, v26
    v_add_f32 v6, v6, v27
    v_add_f32 v6, v6, v28
    v_add_f32 v6, v6, v29
    v_add_f32 v6, v6, v30
    v_add_f32 v6, v6, v31
    v_add_f32 v6, v6, v32
    v_add_f32 v6, v6, v33
    v_add_f32 v6, v6, v34
    v_add_f32 v6, v6, v35
    v_add_f32 v6, v6, v36
    v_add_f32 v6, v6, v37
    v_add_f32 v6, v6, v38
    v_add_f32 v6, v6, v39
    v_cvt_pk_bf16_f32 v24, v24, v25
    v_cvt_pk_bf16_f32 v25, v26, v27
    v_cvt_pk_bf16_f32 v26, v28, v29
    v_cvt_pk_bf16_f32 v27, v30, v31
    v_cvt_pk_bf16_f32 v28, v32, v33
    v_cvt_pk_bf16_f32 v29, v34, v35
    v_cvt_pk_bf16_f32 v30, v36, v37
    v_cvt_pk_bf16_f32 v31, v38, v39
    v_mov_b32 v40, 0
    v_mov_b32 v41, 0
    v_mov_b32 v42, 0
    v_mov_b32 v43, 0
    v_mov_b32 v44, 0
    v_mov_b32 v45, 0
    v_mov_b32 v46, 0
    v_mov_b32 v47, 0
    v_mov_b32 v48, 0
    v_mov_b32 v49, 0
    v_mov_b32 v50, 0
    v_mov_b32 v51, 0
    v_mov_b32 v52, 0
    v_mov_b32 v53, 0
    v_mov_b32 v54, 0
    v_mov_b32 v55, 0
    v_mov_b32 v56, 0
    v_mov_b32 v57, 0
    v_mov_b32 v58, 0
    v_mov_b32 v59, 0
    v_mov_b32 v60, 0
    v_mov_b32 v61, 0
    v_mov_b32 v62, 0
    v_mov_b32 v63, 0
    s_waitcnt vmcnt(45)
    v_and_b32 v9, 0xffff, v24
    v_lshlrev_b32 v10, 16, v24
    v_dot2c_f32_bf16 v40, v64, v9
    v_dot2c_f32_bf16 v41, v64, v10
    v_dot2c_f32_bf16 v42, v65, v9
    v_dot2c_f32_bf16 v43, v65, v10
    v_dot2c_f32_bf16 v44, v66, v9
    v_dot2c_f32_bf16 v45, v66, v10
    v_dot2c_f32_bf16 v46, v67, v9
    v_dot2c_f32_bf16 v47, v67, v10
    v_dot2c_f32_bf16 v48, v68, v9
    v_dot2c_f32_bf16 v49, v68, v10
    v_dot2c_f32_bf16 v50, v69, v9
    v_dot2c_f32_bf16 v51, v69, v10
    v_dot2c_f32_bf16 v52, v70, v9
    v_dot2c_f32_bf16 v53, v70, v10
    v_dot2c_f32_bf16 v54, v71, v9
    v_dot2c_f32_bf16 v55, v71, v10
    v_dot2c_f32_bf16 v56, v72, v9
    v_dot2c_f32_bf16 v57, v72, v10
    v_dot2c_f32_bf16 v58, v73, v9
    v_dot2c_f32_bf16 v59, v73, v10
    v_dot2c_f32_bf16 v60, v74, v9
    v_dot2c_f32_bf16 v61, v74, v10
    v_dot2c_f32_bf16 v62, v75, v9
    v_dot2c_f32_bf16 v63, v75, v10
    s_waitcnt vmcnt(42)
    v_lshrrev_b32 v9, 16, v24
    v_and_b32 v10, 0xffff0000, v24
    v_dot2c_f32_bf16 v40, v76, v9
    v_dot2c_f32_bf16 v41, v76, v10
    v_dot2c_f32_bf16 v42, v77, v9
    v_dot2c_f32_bf16 v43, v77, v10
    v_dot2c_f32_bf16 v44, v78, v9
    v_dot2c_f32_bf16 v45, v78, v10
    v_dot2c_f32_bf16 v46, v79, v9
    v_dot2c_f32_bf16 v47, v79, v10
    v_dot2c_f32_bf16 v48, v80, v9
    v_dot2c_f32_bf16 v49, v80, v10
    v_dot2c_f32_bf16 v50, v81, v9
    v_dot2c_f32_bf16 v51, v81, v10
    v_dot2c_f32_bf16 v52, v82, v9
    v_dot2c_f32_bf16 v53, v82, v10
    v_dot2c_f32_bf16 v54, v83, v9
    v_dot2c_f32_bf16 v55, v83, v10
    v_dot2c_f32_bf16 v56, v84, v9
    v_dot2c_f32_bf16 v57, v84, v10
    v_dot2c_f32_bf16 v58, v85, v9
    v_dot2c_f32_bf16 v59, v85, v10
    v_dot2c_f32_bf16 v60, v86, v9
    v_dot2c_f32_bf16 v61, v86, v10
    v_dot2c_f32_bf16 v62, v87, v9
    v_dot2c_f32_bf16 v63, v87, v10
    s_waitcnt vmcnt(39)
    v_and_b32 v9, 0xffff, v25
    v_lshlrev_b32 v10, 16, v25
    v_dot2c_f32_bf16 v40, v88, v9
    v_dot2c_f32_bf16 v41, v88, v10
    v_dot2c_f32_bf16 v42, v89, v9
    v_dot2c_f32_bf16 v43, v89, v10
    v_dot2c_f32_bf16 v44, v90, v9
    v_dot2c_f32_bf16 v45, v90, v10
    v_dot2c_f32_bf16 v46, v91, v9
    v_dot2c_f32_bf16 v47, v91, v10
    v_dot2c_f32_bf16 v48, v92, v9
    v_dot2c_f32_bf16 v49, v92, v10
    v_dot2c_f32_bf16 v50, v93, v9
    v_dot2c_f32_bf16 v51, v93, v10
    v_dot2c_f32_bf16 v52, v94, v9
    v_dot2c_f32_bf16 v53, v94, v10
    v_dot2c_f32_bf16 v54, v95, v9
    v_dot2c_f32_bf16 v55, v95, v10
    v_dot2c_f32_bf16 v56, v96, v9
    v_dot2c_f32_bf16 v57, v96, v10
    v_dot2c_f32_bf16 v58, v97, v9
    v_dot2c_f32_bf16 v59, v97, v10
    v_dot2c_f32_bf16 v60, v98, v9
    v_dot2c_f32_bf16 v61, v98, v10
    v_dot2c_f32_bf16 v62, v99, v9
    v_dot2c_f32_bf16 v63, v99, v10
    s_waitcnt vmcnt(36)
    v_lshrrev_b32 v9, 16, v25
    v_and_b32 v10, 0xffff0000, v25
    v_dot2c_f32_bf16 v40, v100, v9
    v_dot2c_f32_bf16 v41, v100, v10
    v_dot2c_f32_bf16 v42, v101, v9
    v_dot2c_f32_bf16 v43, v101, v10
    v_dot2c_f32_bf16 v44, v102, v9
    v_dot2c_f32_bf16 v45, v102, v10
    v_dot2c_f32_bf16 v46, v103, v9
    v_dot2c_f32_bf16 v47, v103, v10
    v_dot2c_f32_bf16 v48, v104, v9
    v_dot2c_f32_bf16 v49, v104, v10
    v_dot2c_f32_bf16 v50, v105, v9
    v_dot2c_f32_bf16 v51, v105, v10
    v_dot2c_f32_bf16 v52, v106, v9
    v_dot2c_f32_bf16 v53, v106, v10
    v_dot2c_f32_bf16 v54, v107, v9
    v_dot2c_f32_bf16 v55, v107, v10
    v_dot2c_f32_bf16 v56, v108, v9
    v_dot2c_f32_bf16 v57, v108, v10
    v_dot2c_f32_bf16 v58, v109, v9
    v_dot2c_f32_bf16 v59, v109, v10
    v_dot2c_f32_bf16 v60, v110, v9
    v_dot2c_f32_bf16 v61, v110, v10
    v_dot2c_f32_bf16 v62, v111, v9
    v_dot2c_f32_bf16 v63, v111, v10
    s_waitcnt vmcnt(33)
    v_and_b32 v9, 0xffff, v26
    v_lshlrev_b32 v10, 16, v26
    v_dot2c_f32_bf16 v40, v112, v9
    v_dot2c_f32_bf16 v41, v112, v10
    v_dot2c_f32_bf16 v42, v113, v9
    v_dot2c_f32_bf16 v43, v113, v10
    v_dot2c_f32_bf16 v44, v114, v9
    v_dot2c_f32_bf16 v45, v114, v10
    v_dot2c_f32_bf16 v46, v115, v9
    v_dot2c_f32_bf16 v47, v115, v10
    v_dot2c_f32_bf16 v48, v116, v9
    v_dot2c_f32_bf16 v49, v116, v10
    v_dot2c_f32_bf16 v50, v117, v9
    v_dot2c_f32_bf16 v51, v117, v10
    v_dot2c_f32_bf16 v52, v118, v9
    v_dot2c_f32_bf16 v53, v118, v10
    v_dot2c_f32_bf16 v54, v119, v9
    v_dot2c_f32_bf16 v55, v119, v10
    v_dot2c_f32_bf16 v56, v120, v9
    v_dot2c_f32_bf16 v57, v120, v10
    v_dot2c_f32_bf16 v58, v121, v9
    v_dot2c_f32_bf16 v59, v121, v10
    v_dot2c_f32_bf16 v60, v122, v9
    v_dot2c_f32_bf16 v61, v122, v10
    v_dot2c_f32_bf16 v62, v123, v9
    v_dot2c_f32_bf16 v63, v123, v10
    s_waitcnt vmcnt(30)
    v_lshrrev_b32 v9, 16, v26
    v_and_b32 v10, 0xffff0000, v26
    v_dot2c_f32_bf16 v40, v124, v9
    v_dot2c_f32_bf16 v41, v124, v10
    v_dot2c_f32_bf16 v42, v125, v9
    v_dot2c_f32_bf16 v43, v125, v10
    v_dot2c_f32_bf16 v44, v126, v9
    v_dot2c_f32_bf16 v45, v126, v10
    v_dot2c_f32_bf16 v46, v127, v9
    v_dot2c_f32_bf16 v47, v127, v10
    v_dot2c_f32_bf16 v48, v128, v9
    v_dot2c_f32_bf16 v49, v128, v10
    v_dot2c_f32_bf16 v50, v129, v9
    v_dot2c_f32_bf16 v51, v129, v10
    v_dot2c_f32_bf16 v52, v130, v9
    v_dot2c_f32_bf16 v53, v130, v10
    v_dot2c_f32_bf16 v54, v131, v9
    v_dot2c_f32_bf16 v55, v131, v10
    v_dot2c_f32_bf16 v56, v132, v9
    v_dot2c_f32_bf16 v57, v132, v10
    v_dot2c_f32_bf16 v58, v133, v9
    v_dot2c_f32_bf16 v59, v133, v10
    v_dot2c_f32_bf16 v60, v134, v9
    v_dot2c_f32_bf16 v61, v134, v10
    v_dot2c_f32_bf16 v62, v135, v9
    v_dot2c_f32_bf16 v63, v135, v10
    s_waitcnt vmcnt(27)
    v_and_b32 v9, 0xffff, v27
    v_lshlrev_b32 v10, 16, v27
    v_dot2c_f32_bf16 v40, v136, v9
    v_dot2c_f32_bf16 v41, v136, v10
    v_dot2c_f32_bf16 v42, v137, v9
    v_dot2c_f32_bf16 v43, v137, v10
    v_dot2c_f32_bf16 v44, v138, v9
    v_dot2c_f32_bf16 v45, v138, v10
    v_dot2c_f32_bf16 v46, v139, v9
    v_dot2c_f32_bf16 v47, v139, v10
    v_dot2c_f32_bf16 v48, v140, v9
    v_dot2c_f32_bf16 v49, v140, v10
    v_dot2c_f32_bf16 v50, v141, v9
    v_dot2c_f32_bf16 v51, v141, v10
    v_dot2c_f32_bf16 v52, v142, v9
    v_dot2c_f32_bf16 v53, v142, v10
    v_dot2c_f32_bf16 v54, v143, v9
    v_dot2c_f32_bf16 v55, v143, v10
    v_dot2c_f32_bf16 v56, v144, v9
    v_dot2c_f32_bf16 v57, v144, v10
    v_dot2c_f32_bf16 v58, v145, v9
    v_dot2c_f32_bf16 v59, v145, v10
    v_dot2c_f32_bf16 v60, v146, v9
    v_dot2c_f32_bf16 v61, v146, v10
    v_dot2c_f32_bf16 v62, v147, v9
    v_dot2c_f32_bf16 v63, v147, v10
    s_waitcnt vmcnt(24)
    v_lshrrev_b32 v9, 16, v27
    v_and_b32 v10, 0xffff0000, v27
    v_dot2c_f32_bf16 v40, v148, v9
    v_dot2c_f32_bf16 v41, v148, v10
    v_dot2c_f32_bf16 v42, v149, v9
    v_dot2c_f32_bf16 v43, v149, v10
    v_dot2c_f32_bf16 v44, v150, v9
    v_dot2c_f32_bf16 v45, v150, v10
    v_dot2c_f32_bf16 v46, v151, v9
    v_dot2c_f32_bf16 v47, v151, v10
    v_dot2c_f32_bf16 v48, v152, v9
    v_dot2c_f32_bf16 v49, v152, v10
    v_dot2c_f32_bf16 v50, v153, v9
    v_dot2c_f32_bf16 v51, v153, v10
    v_dot2c_f32_bf16 v52, v154, v9
    v_dot2c_f32_bf16 v53, v154, v10
    v_dot2c_f32_bf16 v54, v155, v9
    v_dot2c_f32_bf16 v55, v155, v10
    v_dot2c_f32_bf16 v56, v156, v9
    v_dot2c_f32_bf16 v57, v156, v10
    v_dot2c_f32_bf16 v58, v157, v9
    v_dot2c_f32_bf16 v59, v157, v10
    v_dot2c_f32_bf16 v60, v158, v9
    v_dot2c_f32_bf16 v61, v158, v10
    v_dot2c_f32_bf16 v62, v159, v9
    v_dot2c_f32_bf16 v63, v159, v10
    s_waitcnt vmcnt(21)
    v_and_b32 v9, 0xffff, v28
    v_lshlrev_b32 v10, 16, v28
    v_dot2c_f32_bf16 v40, v160, v9
    v_dot2c_f32_bf16 v41, v160, v10
    v_dot2c_f32_bf16 v42, v161, v9
    v_dot2c_f32_bf16 v43, v161, v10
    v_dot2c_f32_bf16 v44, v162, v9
    v_dot2c_f32_bf16 v45, v162, v10
    v_dot2c_f32_bf16 v46, v163, v9
    v_dot2c_f32_bf16 v47, v163, v10
    v_dot2c_f32_bf16 v48, v164, v9
    v_dot2c_f32_bf16 v49, v164, v10
    v_dot2c_f32_bf16 v50, v165, v9
    v_dot2c_f32_bf16 v51, v165, v10
    v_dot2c_f32_bf16 v52, v166, v9
    v_dot2c_f32_bf16 v53, v166, v10
    v_dot2c_f32_bf16 v54, v167, v9
    v_dot2c_f32_bf16 v55, v167, v10
    v_dot2c_f32_bf16 v56, v168, v9
    v_dot2c_f32_bf16 v57, v168, v10
    v_dot2c_f32_bf16 v58, v169, v9
    v_dot2c_f32_bf16 v59, v169, v10
    v_dot2c_f32_bf16 v60, v170, v9
    v_dot2c_f32_bf16 v61, v170, v10
    v_dot2c_f32_bf16 v62, v171, v9
    v_dot2c_f32_bf16 v63, v171, v10
    s_waitcnt vmcnt(18)
    v_lshrrev_b32 v9, 16, v28
    v_and_b32 v10, 0xffff0000, v28
    v_dot2c_f32_bf16 v40, v172, v9
    v_dot2c_f32_bf16 v41, v172, v10
    v_dot2c_f32_bf16 v42, v173, v9
    v_dot2c_f32_bf16 v43, v173, v10
    v_dot2c_f32_bf16 v44, v174, v9
    v_dot2c_f32_bf16 v45, v174, v10
    v_dot2c_f32_bf16 v46, v175, v9
    v_dot2c_f32_bf16 v47, v175, v10
    v_dot2c_f32_bf16 v48, v176, v9
    v_dot2c_f32_bf16 v49, v176, v10
    v_dot2c_f32_bf16 v50, v177, v9
    v_dot2c_f32_bf16 v51, v177, v10
    v_dot2c_f32_bf16 v52, v178, v9
    v_dot2c_f32_bf16 v53, v178, v10
    v_dot2c_f32_bf16 v54, v179, v9
    v_dot2c_f32_bf16 v55, v179, v10
    v_dot2c_f32_bf16 v56, v180, v9
    v_dot2c_f32_bf16 v57, v180, v10
    v_dot2c_f32_bf16 v58, v181, v9
    v_dot2c_f32_bf16 v59, v181, v10
    v_dot2c_f32_bf16 v60, v182, v9
    v_dot2c_f32_bf16 v61, v182, v10
    v_dot2c_f32_bf16 v62, v183, v9
    v_dot2c_f32_bf16 v63, v183, v10
    s_waitcnt vmcnt(15)
    v_and_b32 v9, 0xffff, v29
    v_lshlrev_b32 v10, 16, v29
    v_dot2c_f32_bf16 v40, v184, v9
    v_dot2c_f32_bf16 v41, v184, v10
    v_dot2c_f32_bf16 v42, v185, v9
    v_dot2c_f32_bf16 v43, v185, v10
    v_dot2c_f32_bf16 v44, v186, v9
    v_dot2c_f32_bf16 v45, v186, v10
    v_dot2c_f32_bf16 v46, v187, v9
    v_dot2c_f32_bf16 v47, v187, v10
    v_dot2c_f32_bf16 v48, v188, v9
    v_dot2c_f32_bf16 v49, v188, v10
    v_dot2c_f32_bf16 v50, v189, v9
    v_dot2c_f32_bf16 v51, v189, v10
    v_dot2c_f32_bf16 v52, v190, v9
    v_dot2c_f32_bf16 v53, v190, v10
    v_dot2c_f32_bf16 v54, v191, v9
    v_dot2c_f32_bf16 v55, v191, v10
    v_dot2c_f32_bf16 v56, v192, v9
    v_dot2c_f32_bf16 v57, v192, v10
    v_dot2c_f32_bf16 v58, v193, v9
    v_dot2c_f32_bf16 v59, v193, v10
    v_dot2c_f32_bf16 v60, v194, v9
    v_dot2c_f32_bf16 v61, v194, v10
    v_dot2c_f32_bf16 v62, v195, v9
    v_dot2c_f32_bf16 v63, v195, v10
    s_waitcnt vmcnt(12)
    v_lshrrev_b32 v9, 16, v29
    v_and_b32 v10, 0xffff0000, v29
    v_dot2c_f32_bf16 v40, v196, v9
    v_dot2c_f32_bf16 v41, v196, v10
    v_dot2c_f32_bf16 v42, v197, v9
    v_dot2c_f32_bf16 v43, v197, v10
    v_dot2c_f32_bf16 v44, v198, v9
    v_dot2c_f32_bf16 v45, v198, v10
    v_dot2c_f32_bf16 v46, v199, v9
    v_dot2c_f32_bf16 v47, v199, v10
    v_dot2c_f32_bf16 v48, v200, v9
    v_dot2c_f32_bf16 v49, v200, v10
    v_dot2c_f32_bf16 v50, v201, v9
    v_dot2c_f32_bf16 v51, v201, v10
    v_dot2c_f32_bf16 v52, v202, v9
    v_dot2c_f32_bf16 v53, v202, v10
    v_dot2c_f32_bf16 v54, v203, v9
    v_dot2c_f32_bf16 v55, v203, v10
    v_dot2c_f32_bf16 v56, v204, v9
    v_dot2c_f32_bf16 v57, v204, v10
    v_dot2c_f32_bf16 v58, v205, v9
    v_dot2c_f32_bf16 v59, v205, v10
    v_dot2c_f32_bf16 v60, v206, v9
    v_dot2c_f32_bf16 v61, v206, v10
    v_dot2c_f32_bf16 v62, v207, v9
    v_dot2c_f32_bf16 v63, v207, v10
    s_waitcnt vmcnt(9)
    v_and_b32 v9, 0xffff, v30
    v_lshlrev_b32 v10, 16, v30
    v_dot2c_f32_bf16 v40, v208, v9
    v_dot2c_f32_bf16 v41, v208, v10
    v_dot2c_f32_bf16 v42, v209, v9
    v_dot2c_f32_bf16 v43, v209, v10
    v_dot2c_f32_bf16 v44, v210, v9
    v_dot2c_f32_bf16 v45, v210, v10
    v_dot2c_f32_bf16 v46, v211, v9
    v_dot2c_f32_bf16 v47, v211, v10
    v_dot2c_f32_bf16 v48, v212, v9
    v_dot2c_f32_bf16 v49, v212, v10
    v_dot2c_f32_bf16 v50, v213, v9
    v_dot2c_f32_bf16 v51, v213, v10
    v_dot2c_f32_bf16 v52, v214, v9
    v_dot2c_f32_bf16 v53, v214, v10
    v_dot2c_f32_bf16 v54, v215, v9
    v_dot2c_f32_bf16 v55, v215, v10
    v_dot2c_f32_bf16 v56, v216, v9
    v_dot2c_f32_bf16 v57, v216, v10
    v_dot2c_f32_bf16 v58, v217, v9
    v_dot2c_f32_bf16 v59, v217, v10
    v_dot2c_f32_bf16 v60, v218, v9
    v_dot2c_f32_bf16 v61, v218, v10
    v_dot2c_f32_bf16 v62, v219, v9
    v_dot2c_f32_bf16 v63, v219, v10
    s_waitcnt vmcnt(6)
    v_lshrrev_b32 v9, 16, v30
    v_and_b32 v10, 0xffff0000, v30
    v_dot2c_f32_bf16 v40, v220, v9
    v_dot2c_f32_bf16 v41, v220, v10
    v_dot2c_f32_bf16 v42, v221, v9
    v_dot2c_f32_bf16 v43, v221, v10
    v_dot2c_f32_bf16 v44, v222, v9
    v_dot2c_f32_bf16 v45, v222, v10
    v_dot2c_f32_bf16 v46, v223, v9
    v_dot2c_f32_bf16 v47, v223, v10
    v_dot2c_f32_bf16 v48, v224, v9
    v_dot2c_f32_bf16 v49, v224, v10
    v_dot2c_f32_bf16 v50, v225, v9
    v_dot2c_f32_bf16 v51, v225, v10
    v_dot2c_f32_bf16 v52, v226, v9
    v_dot2c_f32_bf16 v53, v226, v10
    v_dot2c_f32_bf16 v54, v227, v9
    v_dot2c_f32_bf16 v55, v227, v10
    v_dot2c_f32_bf16 v56, v228, v9
    v_dot2c_f32_bf16 v57, v228, v10
    v_dot2c_f32_bf16 v58, v229, v9
    v_dot2c_f32_bf16 v59, v229, v10
    v_dot2c_f32_bf16 v60, v230, v9
    v_dot2c_f32_bf16 v61, v230, v10
    v_dot2c_f32_bf16 v62, v231, v9
    v_dot2c_f32_bf16 v63, v231, v10
    s_waitcnt vmcnt(3)
    v_and_b32 v9, 0xffff, v31
    v_lshlrev_b32 v10, 16, v31
    v_dot2c_f32_bf16 v40, v232, v9
    v_dot2c_f32_bf16 v41, v232, v10
    v_dot2c_f32_bf16 v42, v233, v9
    v_dot2c_f32_bf16 v43, v233, v10
    v_dot2c_f32_bf16 v44, v234, v9
    v_dot2c_f32_bf16 v45, v234, v10
    v_dot2c_f32_bf16 v46, v235, v9
    v_dot2c_f32_bf16 v47, v235, v10
    v_dot2c_f32_bf16 v48, v236, v9
    v_dot2c_f32_bf16 v49, v236, v10
    v_dot2c_f32_bf16 v50, v237, v9
    v_dot2c_f32_bf16 v51, v237, v10
    v_dot2c_f32_bf16 v52, v238, v9
    v_dot2c_f32_bf16 v53, v238, v10
    v_dot2c_f32_bf16 v54, v239, v9
    v_dot2c_f32_bf16 v55, v239, v10
    v_dot2c_f32_bf16 v56, v240, v9
    v_dot2c_f32_bf16 v57, v240, v10
    v_dot2c_f32_bf16 v58, v241, v9
    v_dot2c_f32_bf16 v59, v241, v10
    v_dot2c_f32_bf16 v60, v242, v9
    v_dot2c_f32_bf16 v61, v242, v10
    v_dot2c_f32_bf16 v62, v243, v9
    v_dot2c_f32_bf16 v63, v243, v10
    s_waitcnt vmcnt(0)
    v_lshrrev_b32 v9, 16, v31
    v_and_b32 v10, 0xffff0000, v31
    v_dot2c_f32_bf16 v40, v244, v9
    v_dot2c_f32_bf16 v41, v244, v10
    v_dot2c_f32_bf16 v42, v245, v9
    v_dot2c_f32_bf16 v43, v245, v10
    v_dot2c_f32_bf16 v44, v246, v9
    v_dot2c_f32_bf16 v45, v246, v10
    v_dot2c_f32_bf16 v46, v247, v9
    v_dot2c_f32_bf16 v47, v247, v10
    v_dot2c_f32_bf16 v48, v248, v9
    v_dot2c_f32_bf16 v49, v248, v10
    v_dot2c_f32_bf16 v50, v249, v9
    v_dot2c_f32_bf16 v51, v249, v10
    v_dot2c_f32_bf16 v52, v250, v9
    v_dot2c_f32_bf16 v53, v250, v10
    v_dot2c_f32_bf16 v54, v251, v9
    v_dot2c_f32_bf16 v55, v251, v10
    v_dot2c_f32_bf16 v56, v252, v9
    v_dot2c_f32_bf16 v57, v252, v10
    v_dot2c_f32_bf16 v58, v253, v9
    v_dot2c_f32_bf16 v59, v253, v10
    v_dot2c_f32_bf16 v60, v254, v9
    v_dot2c_f32_bf16 v61, v254, v10
    v_dot2c_f32_bf16 v62, v255, v9
    v_dot2c_f32_bf16 v63, v255, v10
    v_and_b32 v9, 15, v1
    v_lshrrev_b32 v10, 4, v1
    v_mul_u32_u24 v244, 192, v10
    v_lshl_add_u32 v244, v9, 4, v244
    v_mov_b32 v11, 768
    v_cmp_gt_u32 vcc, 12, v9
    v_lshlrev_b32 v245, 4, v1
    v_lshlrev_b32 v246, 10, v10
    v_cndmask_b32 v244, v11, v244, vcc
    v_lshl_add_u32 v246, v9, 4, v246
    v_lshlrev_b32 v247, 3, v9
    v_lshl_add_u32 v247, v10, 1, v247
    s_lshl_b32 s82, s81, 7
    v_add_u32 v247, s82, v247
    v_and_b32 v11, 1, v1
    v_lshlrev_b32 v248, 7, v11
    v_lshl_add_u32 v248, v10, 3, v248
    v_mul_u32_u24 v249, 327680, v11
    v_lshl_add_u32 v249, v10, 4, v249
    v_lshlrev_b32 v250, 2, v10
    v_bfe_u32 v11, v1, 2, 2
    v_add_u32 v250, v250, v11
    v_mul_u32_u24 v250, 640, v250
    v_and_b32 v11, 3, v1
    v_lshl_add_u32 v250, v11, 3, v250
    s_sub_u32 s82, s81, 2
    s_lshl_b32 s82, s82, 5
    v_add_u32 v250, s82, v250
    v_mov_b32 v251, 0
    s_lshl_b32 s82, s81, 10
    v_mov_b32 v237, s82
    s_lshl_b32 s82, s81, 2
    v_mov_b32 v238, s82
    s_sub_u32 s82, s81, 2
    s_lshl_b32 s59, s82, 10
    s_lshl_b32 s82, s82, 6
    v_add_u32 v232, s82, v1
    v_mul_u32_u24 v11, 52429, v232
    v_lshrrev_b32 v11, 21, v11
    v_mul_u32_u24 v11, 640, v11
    v_lshl_add_u32 v232, v232, 4, v11
    v_add_u32 v233, s82, v1
    v_add_u32 v233, 384, v233
    v_mul_u32_u24 v11, 52429, v233
    v_lshrrev_b32 v11, 21, v11
    v_mul_u32_u24 v11, 640, v11
    v_lshl_add_u32 v233, v233, 4, v11
    v_add_u32 v234, s82, v1
    v_add_u32 v234, 768, v234
    v_mul_u32_u24 v11, 52429, v234
    v_lshrrev_b32 v11, 21, v11
    v_mul_u32_u24 v11, 640, v11
    v_lshl_add_u32 v234, v234, 4, v11
    v_add_u32 v235, s82, v1
    v_add_u32 v235, 1152, v235
    v_mul_u32_u24 v11, 52429, v235
    v_lshrrev_b32 v11, 21, v11
    v_mul_u32_u24 v11, 640, v11
    v_lshl_add_u32 v235, v235, 4, v11
    v_add_u32 v236, s82, v1
    v_add_u32 v236, 1536, v236
    v_mul_u32_u24 v11, 52429, v236
    v_lshrrev_b32 v11, 21, v11
    v_mul_u32_u24 v11, 640, v11
    v_lshl_add_u32 v236, v236, 4, v11
    v_and_b32 v11, 3, v1
    v_lshlrev_b32 v252, 4, v11
    v_lshl_add_u32 v252, v10, 2, v252
    s_lshl_b32 s82, s81, 6
    v_add_u32 v252, s82, v252
    s_lshl_b32 s52, s94, 10
    s_add_u32 s52, s52, 1048576
    s_lshl_b32 s53, s78, 3
    s_lshl_b32 s82, s81, 2
    s_add_u32 s53, s53, s82
    s_lshl_b32 s53, s53, 10
    s_lshl_b32 s82, s49, 8
    s_add_u32 s53, s53, s82
    s_add_u32 s53, s53, 1048576
    s_mul_i32 s54, s50, 20
    s_add_u32 s54, s54, s81
    s_sub_u32 s54, s54, 2
    s_lshl_b32 s54, s54, 13
    s_lshl_b32 s82, s78, 2
    s_add_u32 s82, s82, s49
    s_lshl_b32 s82, s82, 6
    s_add_u32 s54, s54, s82
    s_add_u32 s54, s54, 2097152
    s_add_u32 s55, s54, 49152
    s_add_u32 s56, s54, 98304
    s_add_u32 s50, s54, 147456
    s_lshl_b32 s57, s94, 13
    s_lshl_b32 s82, s81, 10
    s_add_u32 s57, s57, s82
    s_add_u32 s57, s57, 2097152
    s_cmp_ge_u32 s94, 40
    s_cselect_b32 s82, 40, 0
    s_cselect_b32 s83, 1280, 0
    s_sub_u32 s58, s94, s82
    s_lshl_b32 s58, s58, 5
    s_add_u32 s58, s58, s83
    s_lshl_b32 s82, s81, 2
    v_mov_b32 v11, s82
    s_mov_b32 s95, 0
L_pwait:
    ds_read_b32 v10, v11 offset:42064
    s_waitcnt lgkmcnt(0)
    v_cmp_ne_u32 vcc, 1, v10
    s_nop 4
    s_cmp_eq_u64 vcc, 0
    s_cbranch_scc1 L_pok
    s_add_u32 s95, s95, 1
    s_cmp_gt_u32 s95, 2097152
    s_cbranch_scc1 L_pok
    s_sleep 8
    s_branch L_pwait
L_pok:
    v_mov_b32 v39, 1
    v_mov_b32 v38, 0
    s_mov_b64 exec, 1
    buffer_atomic_add v39, v38, s[40:43], s51 offen sc0 sc1
    s_mov_b64 exec, -1
    s_waitcnt vmcnt(0)
    v_readfirstlane_b32 s82, v39
    s_nop 3
    s_cmp_lt_u32 s82, 64
    s_cbranch_scc1 L_sbA
    s_cmp_lt_u32 s82, 96
    s_cbranch_scc1 L_ssA
    s_cmp_lt_u32 s81, 2
    s_cbranch_scc1 L_nodma1
    s_add_u32 m0, s59, 0
    s_nop 0
    buffer_load_dwordx4 v232, s[36:39], 0 offen nt lds
    s_add_u32 m0, s59, 6144
    s_nop 0
    buffer_load_dwordx4 v233, s[36:39], 0 offen nt lds
    s_add_u32 m0, s59, 12288
    s_nop 0
    buffer_load_dwordx4 v234, s[36:39], 0 offen nt lds
    s_add_u32 m0, s59, 18432
    s_nop 0
    buffer_load_dwordx4 v235, s[36:39], 0 offen nt lds
    s_add_u32 m0, s59, 24576
    s_nop 0
    buffer_load_dwordx4 v236, s[36:39], 0 offen nt lds
L_nodma1:
    v_mov_b32 v11, v6
    s_nop 1
    v_add_f32_dpp v11, v11, v11 row_ror:8 row_mask:0xf bank_mask:0xf
    v_mov_b32 v9, v11
    s_nop 1
    v_permlane16_swap_b32 v11, v9
    v_add_f32 v11, v11, v9
    v_mov_b32 v9, v11
    s_nop 1
    v_permlane32_swap_b32 v11, v9
    v_add_f32 v11, v11, v9
    v_mul_f32 v10, 0x3fb8aa3b, v7
    s_mov_b64 exec, 1
    ds_write_b32 v237, v11 offset:33536
    ds_write_b32 v238, v10 offset:41984
    s_mov_b64 exec, -1
    s_branch L_vdone
L_sbA:
    s_mul_i32 s84, s82, 6144
    s_add_u32 s84, s84, 1081344
    s_add_u32 s85, s84, 3072
    buffer_load_dwordx4 v[64:67], v8, s[20:23], s84 offen offset:0 nt
    buffer_load_dwordx4 v[68:71], v8, s[20:23], s84 offen offset:128 nt
    buffer_load_dwordx4 v[72:75], v8, s[20:23], s84 offen offset:256 nt
    buffer_load_dwordx4 v[76:79], v8, s[20:23], s85 offen offset:0 nt
    buffer_load_dwordx4 v[80:83], v8, s[20:23], s85 offen offset:128 nt
    buffer_load_dwordx4 v[84:87], v8, s[20:23], s85 offen offset:256 nt
    buffer_load_dwordx4 v[88:91], v8, s[24:27], s84 offen offset:0 nt
    buffer_load_dwordx4 v[92:95], v8, s[24:27], s84 offen offset:128 nt
    buffer_load_dwordx4 v[96:99], v8, s[24:27], s84 offen offset:256 nt
    buffer_load_dwordx4 v[100:103], v8, s[24:27], s85 offen offset:0 nt
    buffer_load_dwordx4 v[104:107], v8, s[24:27], s85 offen offset:128 nt
    buffer_load_dwordx4 v[108:111], v8, s[24:27], s85 offen offset:256 nt
    v_mov_b32 v39, 1
    v_mov_b32 v38, 0
    s_mov_b64 exec, 1
    buffer_atomic_add v39, v38, s[40:43], s51 offen sc0 sc1
    s_mov_b64 exec, -1
    s_branch L_bodyXB
L_ssA:
    s_mul_i32 s84, s82, 3072
    s_add_u32 s84, s84, 1277952
    buffer_load_dwordx4 v[64:67], v8, s[20:23], s84 offen offset:0 nt
    buffer_load_dwordx4 v[68:71], v8, s[20:23], s84 offen offset:128 nt
    buffer_load_dwordx4 v[72:75], v8, s[20:23], s84 offen offset:256 nt
    buffer_load_dwordx4 v[88:91], v8, s[24:27], s84 offen offset:0 nt
    buffer_load_dwordx4 v[92:95], v8, s[24:27], s84 offen offset:128 nt
    buffer_load_dwordx4 v[96:99], v8, s[24:27], s84 offen offset:256 nt
    v_mov_b32 v39, 1
    v_mov_b32 v38, 0
    s_mov_b64 exec, 1
    buffer_atomic_add v39, v38, s[40:43], s51 offen sc0 sc1
    s_mov_b64 exec, -1
    s_branch L_bodyXS
L_mainB:
    buffer_load_dwordx4 v[76:79], v2, s[20:23], s53 offen offset:0 nt
    buffer_load_dwordx4 v[80:83], v2, s[20:23], s53 offen offset:128 nt
    s_waitcnt vmcnt(4)
    buffer_load_dwordx4 v[84:87], v2, s[20:23], s53 offen offset:256 nt
    s_waitcnt vmcnt(4)
    buffer_load_dwordx4 v[88:91], v2, s[20:23], s54 offen offset:0 nt
    s_waitcnt vmcnt(4)
    buffer_load_dwordx4 v[92:95], v2, s[20:23], s54 offen offset:128 nt
    s_waitcnt vmcnt(4)
    buffer_load_dwordx4 v[96:99], v2, s[20:23], s54 offen offset:256 nt
    s_waitcnt vmcnt(4)
    buffer_load_dwordx4 v[100:103], v2, s[20:23], s55 offen offset:0 nt
    s_waitcnt vmcnt(4)
    buffer_load_dwordx4 v[104:107], v2, s[20:23], s55 offen offset:128 nt
    s_waitcnt vmcnt(4)
    buffer_load_dwordx4 v[108:111], v2, s[20:23], s55 offen offset:256 nt
    s_waitcnt vmcnt(4)
    buffer_load_dwordx4 v[112:115], v2, s[20:23], s56 offen offset:0 nt
    s_waitcnt vmcnt(4)
    buffer_load_dwordx4 v[116:119], v2, s[20:23], s56 offen offset:128 nt
    s_waitcnt vmcnt(4)
    buffer_load_dwordx4 v[120:123], v2, s[20:23], s56 offen offset:256 nt
    s_waitcnt vmcnt(4)
    buffer_load_dwordx4 v[124:127], v2, s[20:23], s57 offen offset:0 nt
    s_waitcnt vmcnt(4)
    buffer_load_dwordx4 v[128:131], v2, s[20:23], s57 offen offset:128 nt
    s_waitcnt vmcnt(4)
    buffer_load_dwordx4 v[132:135], v2, s[20:23], s57 offen offset:256 nt
    s_waitcnt vmcnt(4)
    buffer_load_dwordx4 v[136:139], v2, s[20:23], s58 offen offset:0 nt
    s_waitcnt vmcnt(4)
    buffer_load_dwordx4 v[140:143], v2, s[20:23], s58 offen offset:128 nt
    s_waitcnt vmcnt(4)
    buffer_load_dwordx4 v[144:147], v2, s[20:23], s58 offen offset:256 nt
    s_waitcnt vmcnt(4)
    buffer_load_dwordx4 v[148:151], v2, s[20:23], s59 offen offset:0 nt
    s_waitcnt vmcnt(4)
    buffer_load_dwordx4 v[152:155], v2, s[20:23], s59 offen offset:128 nt
    s_waitcnt vmcnt(4)
    buffer_load_dwordx4 v[156:159], v2, s[20:23], s59 offen offset:256 nt
    s_waitcnt vmcnt(4)
    buffer_load_dwordx4 v[160:163], v2, s[24:27], s52 offen offset:0 nt
    s_waitcnt vmcnt(4)
    buffer_load_dwordx4 v[164:167], v2, s[24:27], s52 offen offset:128 nt
    s_waitcnt vmcnt(4)
    buffer_load_dwordx4 v[168:171], v2, s[24:27], s52 offen offset:256 nt
    buffer_load_dwordx4 v[172:175], v2, s[24:27], s53 offen offset:0 nt
    buffer_load_dwordx4 v[176:179], v2, s[24:27], s53 offen offset:128 nt
    buffer_load_dwordx4 v[180:183], v2, s[24:27], s53 offen offset:256 nt
    buffer_load_dwordx4 v[184:187], v2, s[24:27], s54 offen offset:0 nt
    buffer_load_dwordx4 v[188:191], v2, s[24:27], s54 offen offset:128 nt
    buffer_load_dwordx4 v[192:195], v2, s[24:27], s54 offen offset:256 nt
    buffer_load_dwordx4 v[196:199], v2, s[24:27], s55 offen offset:0 nt
    buffer_load_dwordx4 v[200:203], v2, s[24:27], s55 offen offset:128 nt
    buffer_load_dwordx4 v[204:207], v2, s[24:27], s55 offen offset:256 nt
    v_and_b32 v9, 7, v1
    v_lshlrev_b32 v10, 5, v9
    v_lshrrev_b32 v11, 3, v1
    v_lshl_add_u32 v10, v11, 2, v10
    s_lshl_b32 s82, s81, 10
    v_add_u32 v5, s82, v10
    v_mov_b32 v24, 0
    v_mov_b32 v25, 0
    v_mov_b32 v26, 0
    v_mov_b32 v27, 0
    v_mov_b32 v28, 0
    v_mov_b32 v29, 0
    v_mov_b32 v30, 0
    v_mov_b32 v31, 0
    v_mov_b32 v11, 0
    s_mov_b32 s95, 0
L_qwaitB:
    ds_read_b32 v10, v11 offset:42048
    s_waitcnt lgkmcnt(0)
    v_cmp_ne_u32 vcc, 1, v10
    s_nop 4
    s_cmp_eq_u64 vcc, 0
    s_cbranch_scc1 L_qreadyB
    s_add_u32 s95, s95, 1
    s_cmp_gt_u32 s95, 2097152
    s_cbranch_scc1 L_qreadyB
    s_sleep 4
    s_branch L_qwaitB
L_qreadyB:
    v_lshlrev_b32 v9, 4, v9
    ds_read_b128 v[12:15], v9 offset:40960
    ds_read_b128 v[16:19], v9 offset:41088
    ds_read_b128 v[20:23], v9 offset:41216
    ds_read_b32 v3, v11 offset:42112
    v_mov_b32 v4, 0xff
    s_waitcnt lgkmcnt(0)
    v_readfirstlane_b32 s48, v3
    v_and_b32 v3, 0xff, v3
    v_mov_b32 v39, 1
    v_mov_b32 v38, 0
    s_mov_b64 exec, 1
    buffer_atomic_add v39, v38, s[40:43], s51 offen sc0 sc1
    s_mov_b64 exec, -1
    buffer_load_dwordx4 v[208:211], v2, s[24:27], s56 offen offset:0 nt
    buffer_load_dwordx4 v[212:215], v2, s[24:27], s56 offen offset:128 nt
    buffer_load_dwordx4 v[216:219], v2, s[24:27], s56 offen offset:256 nt
    buffer_load_dwordx4 v[220:223], v2, s[24:27], s57 offen offset:0 nt
    buffer_load_dwordx4 v[224:227], v2, s[24:27], s57 offen offset:128 nt
    buffer_load_dwordx4 v[228:231], v2, s[24:27], s57 offen offset:256 nt
    buffer_load_dwordx4 v[232:235], v2, s[24:27], s58 offen offset:0 nt
    buffer_load_dwordx4 v[236:239], v2, s[24:27], s58 offen offset:128 nt
    buffer_load_dwordx4 v[240:243], v2, s[24:27], s58 offen offset:256 nt
    buffer_load_dwordx4 v[244:247], v2, s[24:27], s59 offen offset:0 nt
    buffer_load_dwordx4 v[248:251], v2, s[24:27], s59 offen offset:128 nt
    buffer_load_dwordx4 v[252:255], v2, s[24:27], s59 offen offset:256 nt
    s_lshl_b32 s82, s81, 2
    v_mov_b32 v10, s82
    v_mov_b32 v11, 1
    s_mov_b64 exec, 1
    ds_write_b32 v10, v11 offset:42048
    s_mov_b64 exec, -1
    s_waitcnt lgkmcnt(0)
    v_dot2c_f32_bf16 v24, v64, v12
    v_dot2c_f32_bf16 v24, v65, v13
    v_dot2c_f32_bf16 v24, v66, v14
    v_dot2c_f32_bf16 v24, v67, v15
    v_dot2c_f32_bf16 v24, v68, v16
    v_dot2c_f32_bf16 v24, v69, v17
    v_dot2c_f32_bf16 v24, v70, v18
    v_dot2c_f32_bf16 v24, v71, v19
    v_dot2c_f32_bf16 v24, v72, v20
    v_dot2c_f32_bf16 v24, v73, v21
    v_dot2c_f32_bf16 v24, v74, v22
    v_dot2c_f32_bf16 v24, v75, v23
    v_dot2c_f32_bf16 v25, v76, v12
    v_dot2c_f32_bf16 v25, v77, v13
    v_dot2c_f32_bf16 v25, v78, v14
    v_dot2c_f32_bf16 v25, v79, v15
    v_dot2c_f32_bf16 v25, v80, v16
    v_dot2c_f32_bf16 v25, v81, v17
    v_dot2c_f32_bf16 v25, v82, v18
    v_dot2c_f32_bf16 v25, v83, v19
    v_dot2c_f32_bf16 v25, v84, v20
    v_dot2c_f32_bf16 v25, v85, v21
    v_dot2c_f32_bf16 v25, v86, v22
    v_dot2c_f32_bf16 v25, v87, v23
    v_dot2c_f32_bf16 v26, v88, v12
    v_dot2c_f32_bf16 v26, v89, v13
    v_dot2c_f32_bf16 v26, v90, v14
    v_dot2c_f32_bf16 v26, v91, v15
    v_dot2c_f32_bf16 v26, v92, v16
    v_dot2c_f32_bf16 v26, v93, v17
    v_dot2c_f32_bf16 v26, v94, v18
    v_dot2c_f32_bf16 v26, v95, v19
    v_dot2c_f32_bf16 v26, v96, v20
    v_dot2c_f32_bf16 v26, v97, v21
    v_dot2c_f32_bf16 v26, v98, v22
    v_dot2c_f32_bf16 v26, v99, v23
    v_dot2c_f32_bf16 v27, v100, v12
    v_dot2c_f32_bf16 v27, v101, v13
    v_dot2c_f32_bf16 v27, v102, v14
    v_dot2c_f32_bf16 v27, v103, v15
    v_dot2c_f32_bf16 v27, v104, v16
    v_dot2c_f32_bf16 v27, v105, v17
    v_dot2c_f32_bf16 v27, v106, v18
    v_dot2c_f32_bf16 v27, v107, v19
    v_dot2c_f32_bf16 v27, v108, v20
    v_dot2c_f32_bf16 v27, v109, v21
    v_dot2c_f32_bf16 v27, v110, v22
    v_dot2c_f32_bf16 v27, v111, v23
    v_dot2c_f32_bf16 v28, v112, v12
    v_dot2c_f32_bf16 v28, v113, v13
    v_dot2c_f32_bf16 v28, v114, v14
    v_dot2c_f32_bf16 v28, v115, v15
    v_dot2c_f32_bf16 v28, v116, v16
    v_dot2c_f32_bf16 v28, v117, v17
    v_dot2c_f32_bf16 v28, v118, v18
    v_dot2c_f32_bf16 v28, v119, v19
    v_dot2c_f32_bf16 v28, v120, v20
    v_dot2c_f32_bf16 v28, v121, v21
    v_dot2c_f32_bf16 v28, v122, v22
    v_dot2c_f32_bf16 v28, v123, v23
    v_dot2c_f32_bf16 v29, v124, v12
    v_dot2c_f32_bf16 v29, v125, v13
    v_dot2c_f32_bf16 v29, v126, v14
    v_dot2c_f32_bf16 v29, v127, v15
    v_dot2c_f32_bf16 v29, v128, v16
    v_dot2c_f32_bf16 v29, v129, v17
    v_dot2c_f32_bf16 v29, v130, v18
    v_dot2c_f32_bf16 v29, v131, v19
    v_dot2c_f32_bf16 v29, v132, v20
    v_dot2c_f32_bf16 v29, v133, v21
    v_dot2c_f32_bf16 v29, v134, v22
    v_dot2c_f32_bf16 v29, v135, v23
    v_dot2c_f32_bf16 v30, v136, v12
    v_dot2c_f32_bf16 v30, v137, v13
    v_dot2c_f32_bf16 v30, v138, v14
    v_dot2c_f32_bf16 v30, v139, v15
    v_dot2c_f32_bf16 v30, v140, v16
    v_dot2c_f32_bf16 v30, v141, v17
    v_dot2c_f32_bf16 v30, v142, v18
    v_dot2c_f32_bf16 v30, v143, v19
    v_dot2c_f32_bf16 v30, v144, v20
    v_dot2c_f32_bf16 v30, v145, v21
    v_dot2c_f32_bf16 v30, v146, v22
    v_dot2c_f32_bf16 v30, v147, v23
    s_waitcnt vmcnt(25)
    v_dot2c_f32_bf16 v31, v148, v12
    v_dot2c_f32_bf16 v31, v149, v13
    v_dot2c_f32_bf16 v31, v150, v14
    v_dot2c_f32_bf16 v31, v151, v15
    v_dot2c_f32_bf16 v31, v152, v16
    v_dot2c_f32_bf16 v31, v153, v17
    v_dot2c_f32_bf16 v31, v154, v18
    v_dot2c_f32_bf16 v31, v155, v19
    v_dot2c_f32_bf16 v31, v156, v20
    v_dot2c_f32_bf16 v31, v157, v21
    v_dot2c_f32_bf16 v31, v158, v22
    v_dot2c_f32_bf16 v31, v159, v23
    s_nop 2
    v_add_f32_dpp v24, v24, v24 quad_perm:[1,0,3,2] row_mask:0xf bank_mask:0xf
    v_add_f32_dpp v25, v25, v25 quad_perm:[1,0,3,2] row_mask:0xf bank_mask:0xf
    v_add_f32_dpp v26, v26, v26 quad_perm:[1,0,3,2] row_mask:0xf bank_mask:0xf
    v_add_f32_dpp v27, v27, v27 quad_perm:[1,0,3,2] row_mask:0xf bank_mask:0xf
    v_add_f32_dpp v28, v28, v28 quad_perm:[1,0,3,2] row_mask:0xf bank_mask:0xf
    v_add_f32_dpp v29, v29, v29 quad_perm:[1,0,3,2] row_mask:0xf bank_mask:0xf
    v_add_f32_dpp v30, v30, v30 quad_perm:[1,0,3,2] row_mask:0xf bank_mask:0xf
    v_add_f32_dpp v31, v31, v31 quad_perm:[1,0,3,2] row_mask:0xf bank_mask:0xf
    v_add_f32_dpp v24, v24, v24 quad_perm:[2,3,0,1] row_mask:0xf bank_mask:0xf
    v_add_f32_dpp v25, v25, v25 quad_perm:[2,3,0,1] row_mask:0xf bank_mask:0xf
    v_add_f32_dpp v26, v26, v26 quad_perm:[2,3,0,1] row_mask:0xf bank_mask:0xf
    v_add_f32_dpp v27, v27, v27 quad_perm:[2,3,0,1] row_mask:0xf bank_mask:0xf
    v_add_f32_dpp v28, v28, v28 quad_perm:[2,3,0,1] row_mask:0xf bank_mask:0xf
    v_add_f32_dpp v29, v29, v29 quad_perm:[2,3,0,1] row_mask:0xf bank_mask:0xf
    v_add_f32_dpp v30, v30, v30 quad_perm:[2,3,0,1] row_mask:0xf bank_mask:0xf
    v_add_f32_dpp v31, v31, v31 quad_perm:[2,3,0,1] row_mask:0xf bank_mask:0xf
    v_add_f32_dpp v24, v24, v24 row_half_mirror row_mask:0xf bank_mask:0xf
    v_add_f32_dpp v25, v25, v25 row_half_mirror row_mask:0xf bank_mask:0xf
    v_add_f32_dpp v26, v26, v26 row_half_mirror row_mask:0xf bank_mask:0xf
    v_add_f32_dpp v27, v27, v27 row_half_mirror row_mask:0xf bank_mask:0xf
    v_add_f32_dpp v28, v28, v28 row_half_mirror row_mask:0xf bank_mask:0xf
    v_add_f32_dpp v29, v29, v29 row_half_mirror row_mask:0xf bank_mask:0xf
    v_add_f32_dpp v30, v30, v30 row_half_mirror row_mask:0xf bank_mask:0xf
    v_add_f32_dpp v31, v31, v31 row_half_mirror row_mask:0xf bank_mask:0xf
    v_cvt_pk_bf16_f32 v40, v24, v25
    v_cvt_pk_bf16_f32 v41, v26, v27
    v_cvt_pk_bf16_f32 v42, v28, v29
    v_cvt_pk_bf16_f32 v43, v30, v31
    v_lshlrev_b32 v24, 16, v40
    v_and_b32 v25, 0xffff0000, v40
    v_lshlrev_b32 v26, 16, v41
    v_and_b32 v27, 0xffff0000, v41
    v_lshlrev_b32 v28, 16, v42
    v_and_b32 v29, 0xffff0000, v42
    v_lshlrev_b32 v30, 16, v43
    v_and_b32 v31, 0xffff0000, v43
    v_mul_f32 v24, 0x3d93cd3a, v24
    v_mul_f32 v25, 0x3d93cd3a, v25
    v_mul_f32 v26, 0x3d93cd3a, v26
    v_mul_f32 v27, 0x3d93cd3a, v27
    v_mul_f32 v28, 0x3d93cd3a, v28
    v_mul_f32 v29, 0x3d93cd3a, v29
    v_mul_f32 v30, 0x3d93cd3a, v30
    v_mul_f32 v31, 0x3d93cd3a, v31
    v_cvt_pk_bf16_f32 v40, v24, v25
    v_cvt_pk_bf16_f32 v41, v26, v27
    v_cvt_pk_bf16_f32 v42, v28, v29
    v_cvt_pk_bf16_f32 v43, v30, v31
    v_lshlrev_b32 v24, 16, v40
    v_and_b32 v25, 0xffff0000, v40
    v_lshlrev_b32 v26, 16, v41
    v_and_b32 v27, 0xffff0000, v41
    v_lshlrev_b32 v28, 16, v42
    v_and_b32 v29, 0xffff0000, v42
    v_lshlrev_b32 v30, 16, v43
    v_and_b32 v31, 0xffff0000, v43
    v_max3_f32 v7, v24, v25, v26
    v_max3_f32 v7, v7, v27, v28
    v_max3_f32 v7, v7, v29, v30
    v_max_f32 v7, v7, v31
    s_nop 1
    v_max_f32_dpp v7, v7, v7 row_ror:8 row_mask:0xf bank_mask:0xf
    v_mov_b32 v9, v7
    s_nop 1
    v_permlane16_swap_b32 v7, v9
    v_max_f32 v7, v7, v9
    v_mov_b32 v9, v7
    s_nop 1
    v_permlane32_swap_b32 v7, v9
    v_max_f32 v7, v7, v9
    v_sub_f32 v24, v24, v7
    v_sub_f32 v25, v25, v7
    v_sub_f32 v26, v26, v7
    v_sub_f32 v27, v27, v7
    v_sub_f32 v28, v28, v7
    v_sub_f32 v29, v29, v7
    v_sub_f32 v30, v30, v7
    v_sub_f32 v31, v31, v7
    v_mul_f32 v24, 0x3fb8aa3b, v24
    v_mul_f32 v25, 0x3fb8aa3b, v25
    v_mul_f32 v26, 0x3fb8aa3b, v26
    v_mul_f32 v27, 0x3fb8aa3b, v27
    v_mul_f32 v28, 0x3fb8aa3b, v28
    v_mul_f32 v29, 0x3fb8aa3b, v29
    v_mul_f32 v30, 0x3fb8aa3b, v30
    v_mul_f32 v31, 0x3fb8aa3b, v31
    v_exp_f32 v24, v24
    v_exp_f32 v25, v25
    v_exp_f32 v26, v26
    v_exp_f32 v27, v27
    v_exp_f32 v28, v28
    v_exp_f32 v29, v29
    v_exp_f32 v30, v30
    v_exp_f32 v31, v31
    s_nop 0
    v_add_f32 v6, v24, v25
    v_add_f32 v6, v6, v26
    v_add_f32 v6, v6, v27
    v_add_f32 v6, v6, v28
    v_add_f32 v6, v6, v29
    v_add_f32 v6, v6, v30
    v_add_f32 v6, v6, v31
    v_cvt_pk_bf16_f32 v24, v24, v25
    v_cvt_pk_bf16_f32 v25, v26, v27
    v_cvt_pk_bf16_f32 v26, v28, v29
    v_cvt_pk_bf16_f32 v27, v30, v31
    v_mov_b32 v40, 0
    v_mov_b32 v41, 0
    v_mov_b32 v42, 0
    v_mov_b32 v43, 0
    v_mov_b32 v44, 0
    v_mov_b32 v45, 0
    v_mov_b32 v46, 0
    v_mov_b32 v47, 0
    v_mov_b32 v48, 0
    v_mov_b32 v49, 0
    v_mov_b32 v50, 0
    v_mov_b32 v51, 0
    v_mov_b32 v52, 0
    v_mov_b32 v53, 0
    v_mov_b32 v54, 0
    v_mov_b32 v55, 0
    v_mov_b32 v56, 0
    v_mov_b32 v57, 0
    v_mov_b32 v58, 0
    v_mov_b32 v59, 0
    v_mov_b32 v60, 0
    v_mov_b32 v61, 0
    v_mov_b32 v62, 0
    v_mov_b32 v63, 0
    s_waitcnt vmcnt(12)
    v_readfirstlane_b32 s82, v39
    s_nop 3
    s_cmp_lt_u32 s82, 64
    s_cbranch_scc0 L_rare
    s_mul_i32 s84, s82, 6144
    s_add_u32 s84, s84, 1081344
    s_add_u32 s85, s84, 3072
    buffer_load_dwordx4 v[64:67], v8, s[20:23], s84 offen offset:0 nt
    buffer_load_dwordx4 v[68:71], v8, s[20:23], s84 offen offset:128 nt
    buffer_load_dwordx4 v[72:75], v8, s[20:23], s84 offen offset:256 nt
    buffer_load_dwordx4 v[76:79], v8, s[20:23], s85 offen offset:0 nt
    buffer_load_dwordx4 v[80:83], v8, s[20:23], s85 offen offset:128 nt
    buffer_load_dwordx4 v[84:87], v8, s[20:23], s85 offen offset:256 nt
    buffer_load_dwordx4 v[88:91], v8, s[24:27], s84 offen offset:0 nt
    buffer_load_dwordx4 v[92:95], v8, s[24:27], s84 offen offset:128 nt
    buffer_load_dwordx4 v[96:99], v8, s[24:27], s84 offen offset:256 nt
    buffer_load_dwordx4 v[100:103], v8, s[24:27], s85 offen offset:0 nt
    buffer_load_dwordx4 v[104:107], v8, s[24:27], s85 offen offset:128 nt
    buffer_load_dwordx4 v[108:111], v8, s[24:27], s85 offen offset:256 nt
    v_mov_b32 v39, 1
    v_mov_b32 v38, 0
    s_mov_b64 exec, 1
    buffer_atomic_add v39, v38, s[40:43], s51 offen sc0 sc1
    s_mov_b64 exec, -1
    v_and_b32 v9, 0xffff, v24
    v_lshlrev_b32 v10, 16, v24
    v_dot2c_f32_bf16 v40, v160, v9
    v_dot2c_f32_bf16 v41, v160, v10
    v_dot2c_f32_bf16 v42, v161, v9
    v_dot2c_f32_bf16 v43, v161, v10
    v_dot2c_f32_bf16 v44, v162, v9
    v_dot2c_f32_bf16 v45, v162, v10
    v_dot2c_f32_bf16 v46, v163, v9
    v_dot2c_f32_bf16 v47, v163, v10
    v_dot2c_f32_bf16 v48, v164, v9
    v_dot2c_f32_bf16 v49, v164, v10
    v_dot2c_f32_bf16 v50, v165, v9
    v_dot2c_f32_bf16 v51, v165, v10
    v_dot2c_f32_bf16 v52, v166, v9
    v_dot2c_f32_bf16 v53, v166, v10
    v_dot2c_f32_bf16 v54, v167, v9
    v_dot2c_f32_bf16 v55, v167, v10
    v_dot2c_f32_bf16 v56, v168, v9
    v_dot2c_f32_bf16 v57, v168, v10
    v_dot2c_f32_bf16 v58, v169, v9
    v_dot2c_f32_bf16 v59, v169, v10
    v_dot2c_f32_bf16 v60, v170, v9
    v_dot2c_f32_bf16 v61, v170, v10
    v_dot2c_f32_bf16 v62, v171, v9
    v_dot2c_f32_bf16 v63, v171, v10
    v_lshrrev_b32 v9, 16, v24
    v_and_b32 v10, 0xffff0000, v24
    v_dot2c_f32_bf16 v40, v172, v9
    v_dot2c_f32_bf16 v41, v172, v10
    v_dot2c_f32_bf16 v42, v173, v9
    v_dot2c_f32_bf16 v43, v173, v10
    v_dot2c_f32_bf16 v44, v174, v9
    v_dot2c_f32_bf16 v45, v174, v10
    v_dot2c_f32_bf16 v46, v175, v9
    v_dot2c_f32_bf16 v47, v175, v10
    v_dot2c_f32_bf16 v48, v176, v9
    v_dot2c_f32_bf16 v49, v176, v10
    v_dot2c_f32_bf16 v50, v177, v9
    v_dot2c_f32_bf16 v51, v177, v10
    v_dot2c_f32_bf16 v52, v178, v9
    v_dot2c_f32_bf16 v53, v178, v10
    v_dot2c_f32_bf16 v54, v179, v9
    v_dot2c_f32_bf16 v55, v179, v10
    v_dot2c_f32_bf16 v56, v180, v9
    v_dot2c_f32_bf16 v57, v180, v10
    v_dot2c_f32_bf16 v58, v181, v9
    v_dot2c_f32_bf16 v59, v181, v10
    v_dot2c_f32_bf16 v60, v182, v9
    v_dot2c_f32_bf16 v61, v182, v10
    v_dot2c_f32_bf16 v62, v183, v9
    v_dot2c_f32_bf16 v63, v183, v10
    v_and_b32 v9, 0xffff, v25
    v_lshlrev_b32 v10, 16, v25
    v_dot2c_f32_bf16 v40, v184, v9
    v_dot2c_f32_bf16 v41, v184, v10
    v_dot2c_f32_bf16 v42, v185, v9
    v_dot2c_f32_bf16 v43, v185, v10
    v_dot2c_f32_bf16 v44, v186, v9
    v_dot2c_f32_bf16 v45, v186, v10
    v_dot2c_f32_bf16 v46, v187, v9
    v_dot2c_f32_bf16 v47, v187, v10
    v_dot2c_f32_bf16 v48, v188, v9
    v_dot2c_f32_bf16 v49, v188, v10
    v_dot2c_f32_bf16 v50, v189, v9
    v_dot2c_f32_bf16 v51, v189, v10
    v_dot2c_f32_bf16 v52, v190, v9
    v_dot2c_f32_bf16 v53, v190, v10
    v_dot2c_f32_bf16 v54, v191, v9
    v_dot2c_f32_bf16 v55, v191, v10
    v_dot2c_f32_bf16 v56, v192, v9
    v_dot2c_f32_bf16 v57, v192, v10
    v_dot2c_f32_bf16 v58, v193, v9
    v_dot2c_f32_bf16 v59, v193, v10
    v_dot2c_f32_bf16 v60, v194, v9
    v_dot2c_f32_bf16 v61, v194, v10
    v_dot2c_f32_bf16 v62, v195, v9
    v_dot2c_f32_bf16 v63, v195, v10
    v_lshrrev_b32 v9, 16, v25
    v_and_b32 v10, 0xffff0000, v25
    v_dot2c_f32_bf16 v40, v196, v9
    v_dot2c_f32_bf16 v41, v196, v10
    v_dot2c_f32_bf16 v42, v197, v9
    v_dot2c_f32_bf16 v43, v197, v10
    v_dot2c_f32_bf16 v44, v198, v9
    v_dot2c_f32_bf16 v45, v198, v10
    v_dot2c_f32_bf16 v46, v199, v9
    v_dot2c_f32_bf16 v47, v199, v10
    v_dot2c_f32_bf16 v48, v200, v9
    v_dot2c_f32_bf16 v49, v200, v10
    v_dot2c_f32_bf16 v50, v201, v9
    v_dot2c_f32_bf16 v51, v201, v10
    v_dot2c_f32_bf16 v52, v202, v9
    v_dot2c_f32_bf16 v53, v202, v10
    v_dot2c_f32_bf16 v54, v203, v9
    v_dot2c_f32_bf16 v55, v203, v10
    v_dot2c_f32_bf16 v56, v204, v9
    v_dot2c_f32_bf16 v57, v204, v10
    v_dot2c_f32_bf16 v58, v205, v9
    v_dot2c_f32_bf16 v59, v205, v10
    v_dot2c_f32_bf16 v60, v206, v9
    v_dot2c_f32_bf16 v61, v206, v10
    v_dot2c_f32_bf16 v62, v207, v9
    v_dot2c_f32_bf16 v63, v207, v10
    s_waitcnt vmcnt(22)
    v_and_b32 v9, 0xffff, v26
    v_lshlrev_b32 v10, 16, v26
    v_dot2c_f32_bf16 v40, v208, v9
    v_dot2c_f32_bf16 v41, v208, v10
    v_dot2c_f32_bf16 v42, v209, v9
    v_dot2c_f32_bf16 v43, v209, v10
    v_dot2c_f32_bf16 v44, v210, v9
    v_dot2c_f32_bf16 v45, v210, v10
    v_dot2c_f32_bf16 v46, v211, v9
    v_dot2c_f32_bf16 v47, v211, v10
    v_dot2c_f32_bf16 v48, v212, v9
    v_dot2c_f32_bf16 v49, v212, v10
    v_dot2c_f32_bf16 v50, v213, v9
    v_dot2c_f32_bf16 v51, v213, v10
    v_dot2c_f32_bf16 v52, v214, v9
    v_dot2c_f32_bf16 v53, v214, v10
    v_dot2c_f32_bf16 v54, v215, v9
    v_dot2c_f32_bf16 v55, v215, v10
    v_dot2c_f32_bf16 v56, v216, v9
    v_dot2c_f32_bf16 v57, v216, v10
    v_dot2c_f32_bf16 v58, v217, v9
    v_dot2c_f32_bf16 v59, v217, v10
    v_dot2c_f32_bf16 v60, v218, v9
    v_dot2c_f32_bf16 v61, v218, v10
    v_dot2c_f32_bf16 v62, v219, v9
    v_dot2c_f32_bf16 v63, v219, v10
    s_waitcnt vmcnt(19)
    v_lshrrev_b32 v9, 16, v26
    v_and_b32 v10, 0xffff0000, v26
    v_dot2c_f32_bf16 v40, v220, v9
    v_dot2c_f32_bf16 v41, v220, v10
    v_dot2c_f32_bf16 v42, v221, v9
    v_dot2c_f32_bf16 v43, v221, v10
    v_dot2c_f32_bf16 v44, v222, v9
    v_dot2c_f32_bf16 v45, v222, v10
    v_dot2c_f32_bf16 v46, v223, v9
    v_dot2c_f32_bf16 v47, v223, v10
    v_dot2c_f32_bf16 v48, v224, v9
    v_dot2c_f32_bf16 v49, v224, v10
    v_dot2c_f32_bf16 v50, v225, v9
    v_dot2c_f32_bf16 v51, v225, v10
    v_dot2c_f32_bf16 v52, v226, v9
    v_dot2c_f32_bf16 v53, v226, v10
    v_dot2c_f32_bf16 v54, v227, v9
    v_dot2c_f32_bf16 v55, v227, v10
    v_dot2c_f32_bf16 v56, v228, v9
    v_dot2c_f32_bf16 v57, v228, v10
    v_dot2c_f32_bf16 v58, v229, v9
    v_dot2c_f32_bf16 v59, v229, v10
    v_dot2c_f32_bf16 v60, v230, v9
    v_dot2c_f32_bf16 v61, v230, v10
    v_dot2c_f32_bf16 v62, v231, v9
    v_dot2c_f32_bf16 v63, v231, v10
    s_waitcnt vmcnt(16)
    v_and_b32 v9, 0xffff, v27
    v_lshlrev_b32 v10, 16, v27
    v_dot2c_f32_bf16 v40, v232, v9
    v_dot2c_f32_bf16 v41, v232, v10
    v_dot2c_f32_bf16 v42, v233, v9
    v_dot2c_f32_bf16 v43, v233, v10
    v_dot2c_f32_bf16 v44, v234, v9
    v_dot2c_f32_bf16 v45, v234, v10
    v_dot2c_f32_bf16 v46, v235, v9
    v_dot2c_f32_bf16 v47, v235, v10
    v_dot2c_f32_bf16 v48, v236, v9
    v_dot2c_f32_bf16 v49, v236, v10
    v_dot2c_f32_bf16 v50, v237, v9
    v_dot2c_f32_bf16 v51, v237, v10
    v_dot2c_f32_bf16 v52, v238, v9
    v_dot2c_f32_bf16 v53, v238, v10
    v_dot2c_f32_bf16 v54, v239, v9
    v_dot2c_f32_bf16 v55, v239, v10
    v_dot2c_f32_bf16 v56, v240, v9
    v_dot2c_f32_bf16 v57, v240, v10
    v_dot2c_f32_bf16 v58, v241, v9
    v_dot2c_f32_bf16 v59, v241, v10
    v_dot2c_f32_bf16 v60, v242, v9
    v_dot2c_f32_bf16 v61, v242, v10
    v_dot2c_f32_bf16 v62, v243, v9
    v_dot2c_f32_bf16 v63, v243, v10
    s_waitcnt vmcnt(13)
    v_lshrrev_b32 v9, 16, v27
    v_and_b32 v10, 0xffff0000, v27
    v_dot2c_f32_bf16 v40, v244, v9
    v_dot2c_f32_bf16 v41, v244, v10
    v_dot2c_f32_bf16 v42, v245, v9
    v_dot2c_f32_bf16 v43, v245, v10
    v_dot2c_f32_bf16 v44, v246, v9
    v_dot2c_f32_bf16 v45, v246, v10
    v_dot2c_f32_bf16 v46, v247, v9
    v_dot2c_f32_bf16 v47, v247, v10
    v_dot2c_f32_bf16 v48, v248, v9
    v_dot2c_f32_bf16 v49, v248, v10
    v_dot2c_f32_bf16 v50, v249, v9
    v_dot2c_f32_bf16 v51, v249, v10
    v_dot2c_f32_bf16 v52, v250, v9
    v_dot2c_f32_bf16 v53, v250, v10
    v_dot2c_f32_bf16 v54, v251, v9
    v_dot2c_f32_bf16 v55, v251, v10
    v_dot2c_f32_bf16 v56, v252, v9
    v_dot2c_f32_bf16 v57, v252, v10
    v_dot2c_f32_bf16 v58, v253, v9
    v_dot2c_f32_bf16 v59, v253, v10
    v_dot2c_f32_bf16 v60, v254, v9
    v_dot2c_f32_bf16 v61, v254, v10
    v_dot2c_f32_bf16 v62, v255, v9
    v_dot2c_f32_bf16 v63, v255, v10
    v_and_b32 v9, 15, v1
    v_lshrrev_b32 v10, 4, v1
    v_mul_u32_u24 v244, 192, v10
    v_lshl_add_u32 v244, v9, 4, v244
    v_mov_b32 v11, 768
    v_cmp_gt_u32 vcc, 12, v9
    v_lshlrev_b32 v245, 4, v1
    v_lshlrev_b32 v246, 10, v10
    v_cndmask_b32 v244, v11, v244, vcc
    v_lshl_add_u32 v246, v9, 4, v246
    v_lshlrev_b32 v247, 3, v9
    v_lshl_add_u32 v247, v10, 1, v247
    s_lshl_b32 s82, s81, 7
    v_add_u32 v247, s82, v247
    v_and_b32 v11, 1, v1
    v_lshlrev_b32 v248, 7, v11
    v_lshl_add_u32 v248, v10, 3, v248
    v_mul_u32_u24 v249, 327680, v11
    v_lshl_add_u32 v249, v10, 4, v249
    v_lshlrev_b32 v250, 2, v10
    v_bfe_u32 v11, v1, 2, 2
    v_add_u32 v250, v250, v11
    v_mul_u32_u24 v250, 640, v250
    v_and_b32 v11, 3, v1
    v_lshl_add_u32 v250, v11, 3, v250
    s_sub_u32 s82, s81, 2
    s_lshl_b32 s82, s82, 5
    v_add_u32 v250, s82, v250
    v_mov_b32 v251, 0
    s_lshl_b32 s82, s81, 10
    v_mov_b32 v237, s82
    s_lshl_b32 s82, s81, 2
    v_mov_b32 v238, s82
    s_sub_u32 s82, s81, 2
    s_lshl_b32 s59, s82, 10
    s_lshl_b32 s82, s82, 6
    v_add_u32 v232, s82, v1
    v_mul_u32_u24 v11, 52429, v232
    v_lshrrev_b32 v11, 21, v11
    v_mul_u32_u24 v11, 640, v11
    v_lshl_add_u32 v232, v232, 4, v11
    v_add_u32 v233, s82, v1
    v_add_u32 v233, 384, v233
    v_mul_u32_u24 v11, 52429, v233
    v_lshrrev_b32 v11, 21, v11
    v_mul_u32_u24 v11, 640, v11
    v_lshl_add_u32 v233, v233, 4, v11
    v_add_u32 v234, s82, v1
    v_add_u32 v234, 768, v234
    v_mul_u32_u24 v11, 52429, v234
    v_lshrrev_b32 v11, 21, v11
    v_mul_u32_u24 v11, 640, v11
    v_lshl_add_u32 v234, v234, 4, v11
    v_add_u32 v235, s82, v1
    v_add_u32 v235, 1152, v235
    v_mul_u32_u24 v11, 52429, v235
    v_lshrrev_b32 v11, 21, v11
    v_mul_u32_u24 v11, 640, v11
    v_lshl_add_u32 v235, v235, 4, v11
    v_add_u32 v236, s82, v1
    v_add_u32 v236, 1536, v236
    v_mul_u32_u24 v11, 52429, v236
    v_lshrrev_b32 v11, 21, v11
    v_mul_u32_u24 v11, 640, v11
    v_lshl_add_u32 v236, v236, 4, v11
    v_and_b32 v11, 3, v1
    v_lshlrev_b32 v252, 4, v11
    v_lshl_add_u32 v252, v10, 2, v252
    s_lshl_b32 s82, s81, 6
    v_add_u32 v252, s82, v252
    s_lshl_b32 s52, s94, 10
    s_add_u32 s52, s52, 1048576
    s_lshl_b32 s53, s78, 3
    s_lshl_b32 s82, s81, 2
    s_add_u32 s53, s53, s82
    s_lshl_b32 s53, s53, 10
    s_lshl_b32 s82, s49, 8
    s_add_u32 s53, s53, s82
    s_add_u32 s53, s53, 1048576
    s_mul_i32 s54, s50, 20
    s_add_u32 s54, s54, s81
    s_sub_u32 s54, s54, 2
    s_lshl_b32 s54, s54, 13
    s_lshl_b32 s82, s78, 2
    s_add_u32 s82, s82, s49
    s_lshl_b32 s82, s82, 6
    s_add_u32 s54, s54, s82
    s_add_u32 s54, s54, 2097152
    s_add_u32 s55, s54, 49152
    s_add_u32 s56, s54, 98304
    s_add_u32 s50, s54, 147456
    s_lshl_b32 s57, s94, 13
    s_lshl_b32 s82, s81, 10
    s_add_u32 s57, s57, s82
    s_add_u32 s57, s57, 2097152
    s_cmp_ge_u32 s94, 40
    s_cselect_b32 s82, 40, 0
    s_cselect_b32 s83, 1280, 0
    s_sub_u32 s58, s94, s82
    s_lshl_b32 s58, s58, 5
    s_add_u32 s58, s58, s83
    s_branch L_bodyXB
L_rare:
    s_mov_b32 s86, s82
    v_and_b32 v9, 0xffff, v24
    v_lshlrev_b32 v10, 16, v24
    v_dot2c_f32_bf16 v40, v160, v9
    v_dot2c_f32_bf16 v41, v160, v10
    v_dot2c_f32_bf16 v42, v161, v9
    v_dot2c_f32_bf16 v43, v161, v10
    v_dot2c_f32_bf16 v44, v162, v9
    v_dot2c_f32_bf16 v45, v162, v10
    v_dot2c_f32_bf16 v46, v163, v9
    v_dot2c_f32_bf16 v47, v163, v10
    v_dot2c_f32_bf16 v48, v164, v9
    v_dot2c_f32_bf16 v49, v164, v10
    v_dot2c_f32_bf16 v50, v165, v9
    v_dot2c_f32_bf16 v51, v165, v10
    v_dot2c_f32_bf16 v52, v166, v9
    v_dot2c_f32_bf16 v53, v166, v10
    v_dot2c_f32_bf16 v54, v167, v9
    v_dot2c_f32_bf16 v55, v167, v10
    v_dot2c_f32_bf16 v56, v168, v9
    v_dot2c_f32_bf16 v57, v168, v10
    v_dot2c_f32_bf16 v58, v169, v9
    v_dot2c_f32_bf16 v59, v169, v10
    v_dot2c_f32_bf16 v60, v170, v9
    v_dot2c_f32_bf16 v61, v170, v10
    v_dot2c_f32_bf16 v62, v171, v9
    v_dot2c_f32_bf16 v63, v171, v10
    v_lshrrev_b32 v9, 16, v24
    v_and_b32 v10, 0xffff0000, v24
    v_dot2c_f32_bf16 v40, v172, v9
    v_dot2c_f32_bf16 v41, v172, v10
    v_dot2c_f32_bf16 v42, v173, v9
    v_dot2c_f32_bf16 v43, v173, v10
    v_dot2c_f32_bf16 v44, v174, v9
    v_dot2c_f32_bf16 v45, v174, v10
    v_dot2c_f32_bf16 v46, v175, v9
    v_dot2c_f32_bf16 v47, v175, v10
    v_dot2c_f32_bf16 v48, v176, v9
    v_dot2c_f32_bf16 v49, v176, v10
    v_dot2c_f32_bf16 v50, v177, v9
    v_dot2c_f32_bf16 v51, v177, v10
    v_dot2c_f32_bf16 v52, v178, v9
    v_dot2c_f32_bf16 v53, v178, v10
    v_dot2c_f32_bf16 v54, v179, v9
    v_dot2c_f32_bf16 v55, v179, v10
    v_dot2c_f32_bf16 v56, v180, v9
    v_dot2c_f32_bf16 v57, v180, v10
    v_dot2c_f32_bf16 v58, v181, v9
    v_dot2c_f32_bf16 v59, v181, v10
    v_dot2c_f32_bf16 v60, v182, v9
    v_dot2c_f32_bf16 v61, v182, v10
    v_dot2c_f32_bf16 v62, v183, v9
    v_dot2c_f32_bf16 v63, v183, v10
    v_and_b32 v9, 0xffff, v25
    v_lshlrev_b32 v10, 16, v25
    v_dot2c_f32_bf16 v40, v184, v9
    v_dot2c_f32_bf16 v41, v184, v10
    v_dot2c_f32_bf16 v42, v185, v9
    v_dot2c_f32_bf16 v43, v185, v10
    v_dot2c_f32_bf16 v44, v186, v9
    v_dot2c_f32_bf16 v45, v186, v10
    v_dot2c_f32_bf16 v46, v187, v9
    v_dot2c_f32_bf16 v47, v187, v10
    v_dot2c_f32_bf16 v48, v188, v9
    v_dot2c_f32_bf16 v49, v188, v10
    v_dot2c_f32_bf16 v50, v189, v9
    v_dot2c_f32_bf16 v51, v189, v10
    v_dot2c_f32_bf16 v52, v190, v9
    v_dot2c_f32_bf16 v53, v190, v10
    v_dot2c_f32_bf16 v54, v191, v9
    v_dot2c_f32_bf16 v55, v191, v10
    v_dot2c_f32_bf16 v56, v192, v9
    v_dot2c_f32_bf16 v57, v192, v10
    v_dot2c_f32_bf16 v58, v193, v9
    v_dot2c_f32_bf16 v59, v193, v10
    v_dot2c_f32_bf16 v60, v194, v9
    v_dot2c_f32_bf16 v61, v194, v10
    v_dot2c_f32_bf16 v62, v195, v9
    v_dot2c_f32_bf16 v63, v195, v10
    v_lshrrev_b32 v9, 16, v25
    v_and_b32 v10, 0xffff0000, v25
    v_dot2c_f32_bf16 v40, v196, v9
    v_dot2c_f32_bf16 v41, v196, v10
    v_dot2c_f32_bf16 v42, v197, v9
    v_dot2c_f32_bf16 v43, v197, v10
    v_dot2c_f32_bf16 v44, v198, v9
    v_dot2c_f32_bf16 v45, v198, v10
    v_dot2c_f32_bf16 v46, v199, v9
    v_dot2c_f32_bf16 v47, v199, v10
    v_dot2c_f32_bf16 v48, v200, v9
    v_dot2c_f32_bf16 v49, v200, v10
    v_dot2c_f32_bf16 v50, v201, v9
    v_dot2c_f32_bf16 v51, v201, v10
    v_dot2c_f32_bf16 v52, v202, v9
    v_dot2c_f32_bf16 v53, v202, v10
    v_dot2c_f32_bf16 v54, v203, v9
    v_dot2c_f32_bf16 v55, v203, v10
    v_dot2c_f32_bf16 v56, v204, v9
    v_dot2c_f32_bf16 v57, v204, v10
    v_dot2c_f32_bf16 v58, v205, v9
    v_dot2c_f32_bf16 v59, v205, v10
    v_dot2c_f32_bf16 v60, v206, v9
    v_dot2c_f32_bf16 v61, v206, v10
    v_dot2c_f32_bf16 v62, v207, v9
    v_dot2c_f32_bf16 v63, v207, v10
    s_waitcnt vmcnt(9)
    v_and_b32 v9, 0xffff, v26
    v_lshlrev_b32 v10, 16, v26
    v_dot2c_f32_bf16 v40, v208, v9
    v_dot2c_f32_bf16 v41, v208, v10
    v_dot2c_f32_bf16 v42, v209, v9
    v_dot2c_f32_bf16 v43, v209, v10
    v_dot2c_f32_bf16 v44, v210, v9
    v_dot2c_f32_bf16 v45, v210, v10
    v_dot2c_f32_bf16 v46, v211, v9
    v_dot2c_f32_bf16 v47, v211, v10
    v_dot2c_f32_bf16 v48, v212, v9
    v_dot2c_f32_bf16 v49, v212, v10
    v_dot2c_f32_bf16 v50, v213, v9
    v_dot2c_f32_bf16 v51, v213, v10
    v_dot2c_f32_bf16 v52, v214, v9
    v_dot2c_f32_bf16 v53, v214, v10
    v_dot2c_f32_bf16 v54, v215, v9
    v_dot2c_f32_bf16 v55, v215, v10
    v_dot2c_f32_bf16 v56, v216, v9
    v_dot2c_f32_bf16 v57, v216, v10
    v_dot2c_f32_bf16 v58, v217, v9
    v_dot2c_f32_bf16 v59, v217, v10
    v_dot2c_f32_bf16 v60, v218, v9
    v_dot2c_f32_bf16 v61, v218, v10
    v_dot2c_f32_bf16 v62, v219, v9
    v_dot2c_f32_bf16 v63, v219, v10
    s_waitcnt vmcnt(6)
    v_lshrrev_b32 v9, 16, v26
    v_and_b32 v10, 0xffff0000, v26
    v_dot2c_f32_bf16 v40, v220, v9
    v_dot2c_f32_bf16 v41, v220, v10
    v_dot2c_f32_bf16 v42, v221, v9
    v_dot2c_f32_bf16 v43, v221, v10
    v_dot2c_f32_bf16 v44, v222, v9
    v_dot2c_f32_bf16 v45, v222, v10
    v_dot2c_f32_bf16 v46, v223, v9
    v_dot2c_f32_bf16 v47, v223, v10
    v_dot2c_f32_bf16 v48, v224, v9
    v_dot2c_f32_bf16 v49, v224, v10
    v_dot2c_f32_bf16 v50, v225, v9
    v_dot2c_f32_bf16 v51, v225, v10
    v_dot2c_f32_bf16 v52, v226, v9
    v_dot2c_f32_bf16 v53, v226, v10
    v_dot2c_f32_bf16 v54, v227, v9
    v_dot2c_f32_bf16 v55, v227, v10
    v_dot2c_f32_bf16 v56, v228, v9
    v_dot2c_f32_bf16 v57, v228, v10
    v_dot2c_f32_bf16 v58, v229, v9
    v_dot2c_f32_bf16 v59, v229, v10
    v_dot2c_f32_bf16 v60, v230, v9
    v_dot2c_f32_bf16 v61, v230, v10
    v_dot2c_f32_bf16 v62, v231, v9
    v_dot2c_f32_bf16 v63, v231, v10
    s_waitcnt vmcnt(3)
    v_and_b32 v9, 0xffff, v27
    v_lshlrev_b32 v10, 16, v27
    v_dot2c_f32_bf16 v40, v232, v9
    v_dot2c_f32_bf16 v41, v232, v10
    v_dot2c_f32_bf16 v42, v233, v9
    v_dot2c_f32_bf16 v43, v233, v10
    v_dot2c_f32_bf16 v44, v234, v9
    v_dot2c_f32_bf16 v45, v234, v10
    v_dot2c_f32_bf16 v46, v235, v9
    v_dot2c_f32_bf16 v47, v235, v10
    v_dot2c_f32_bf16 v48, v236, v9
    v_dot2c_f32_bf16 v49, v236, v10
    v_dot2c_f32_bf16 v50, v237, v9
    v_dot2c_f32_bf16 v51, v237, v10
    v_dot2c_f32_bf16 v52, v238, v9
    v_dot2c_f32_bf16 v53, v238, v10
    v_dot2c_f32_bf16 v54, v239, v9
    v_dot2c_f32_bf16 v55, v239, v10
    v_dot2c_f32_bf16 v56, v240, v9
    v_dot2c_f32_bf16 v57, v240, v10
    v_dot2c_f32_bf16 v58, v241, v9
    v_dot2c_f32_bf16 v59, v241, v10
    v_dot2c_f32_bf16 v60, v242, v9
    v_dot2c_f32_bf16 v61, v242, v10
    v_dot2c_f32_bf16 v62, v243, v9
    v_dot2c_f32_bf16 v63, v243, v10
    s_waitcnt vmcnt(0)
    v_lshrrev_b32 v9, 16, v27
    v_and_b32 v10, 0xffff0000, v27
    v_dot2c_f32_bf16 v40, v244, v9
    v_dot2c_f32_bf16 v41, v244, v10
    v_dot2c_f32_bf16 v42, v245, v9
    v_dot2c_f32_bf16 v43, v245, v10
    v_dot2c_f32_bf16 v44, v246, v9
    v_dot2c_f32_bf16 v45, v246, v10
    v_dot2c_f32_bf16 v46, v247, v9
    v_dot2c_f32_bf16 v47, v247, v10
    v_dot2c_f32_bf16 v48, v248, v9
    v_dot2c_f32_bf16 v49, v248, v10
    v_dot2c_f32_bf16 v50, v249, v9
    v_dot2c_f32_bf16 v51, v249, v10
    v_dot2c_f32_bf16 v52, v250, v9
    v_dot2c_f32_bf16 v53, v250, v10
    v_dot2c_f32_bf16 v54, v251, v9
    v_dot2c_f32_bf16 v55, v251, v10
    v_dot2c_f32_bf16 v56, v252, v9
    v_dot2c_f32_bf16 v57, v252, v10
    v_dot2c_f32_bf16 v58, v253, v9
    v_dot2c_f32_bf16 v59, v253, v10
    v_dot2c_f32_bf16 v60, v254, v9
    v_dot2c_f32_bf16 v61, v254, v10
    v_dot2c_f32_bf16 v62, v255, v9
    v_dot2c_f32_bf16 v63, v255, v10
    v_and_b32 v9, 15, v1
    v_lshrrev_b32 v10, 4, v1
    v_mul_u32_u24 v244, 192, v10
    v_lshl_add_u32 v244, v9, 4, v244
    v_mov_b32 v11, 768
    v_cmp_gt_u32 vcc, 12, v9
    v_lshlrev_b32 v245, 4, v1
    v_lshlrev_b32 v246, 10, v10
    v_cndmask_b32 v244, v11, v244, vcc
    v_lshl_add_u32 v246, v9, 4, v246
    v_lshlrev_b32 v247, 3, v9
    v_lshl_add_u32 v247, v10, 1, v247
    s_lshl_b32 s82, s81, 7
    v_add_u32 v247, s82, v247
    v_and_b32 v11, 1, v1
    v_lshlrev_b32 v248, 7, v11
    v_lshl_add_u32 v248, v10, 3, v248
    v_mul_u32_u24 v249, 327680, v11
    v_lshl_add_u32 v249, v10, 4, v249
    v_lshlrev_b32 v250, 2, v10
    v_bfe_u32 v11, v1, 2, 2
    v_add_u32 v250, v250, v11
    v_mul_u32_u24 v250, 640, v250
    v_and_b32 v11, 3, v1
    v_lshl_add_u32 v250, v11, 3, v250
    s_sub_u32 s82, s81, 2
    s_lshl_b32 s82, s82, 5
    v_add_u32 v250, s82, v250
    v_mov_b32 v251, 0
    s_lshl_b32 s82, s81, 10
    v_mov_b32 v237, s82
    s_lshl_b32 s82, s81, 2
    v_mov_b32 v238, s82
    s_sub_u32 s82, s81, 2
    s_lshl_b32 s59, s82, 10
    s_lshl_b32 s82, s82, 6
    v_add_u32 v232, s82, v1
    v_mul_u32_u24 v11, 52429, v232
    v_lshrrev_b32 v11, 21, v11
    v_mul_u32_u24 v11, 640, v11
    v_lshl_add_u32 v232, v232, 4, v11
    v_add_u32 v233, s82, v1
    v_add_u32 v233, 384, v233
    v_mul_u32_u24 v11, 52429, v233
    v_lshrrev_b32 v11, 21, v11
    v_mul_u32_u24 v11, 640, v11
    v_lshl_add_u32 v233, v233, 4, v11
    v_add_u32 v234, s82, v1
    v_add_u32 v234, 768, v234
    v_mul_u32_u24 v11, 52429, v234
    v_lshrrev_b32 v11, 21, v11
    v_mul_u32_u24 v11, 640, v11
    v_lshl_add_u32 v234, v234, 4, v11
    v_add_u32 v235, s82, v1
    v_add_u32 v235, 1152, v235
    v_mul_u32_u24 v11, 52429, v235
    v_lshrrev_b32 v11, 21, v11
    v_mul_u32_u24 v11, 640, v11
    v_lshl_add_u32 v235, v235, 4, v11
    v_add_u32 v236, s82, v1
    v_add_u32 v236, 1536, v236
    v_mul_u32_u24 v11, 52429, v236
    v_lshrrev_b32 v11, 21, v11
    v_mul_u32_u24 v11, 640, v11
    v_lshl_add_u32 v236, v236, 4, v11
    v_and_b32 v11, 3, v1
    v_lshlrev_b32 v252, 4, v11
    v_lshl_add_u32 v252, v10, 2, v252
    s_lshl_b32 s82, s81, 6
    v_add_u32 v252, s82, v252
    s_lshl_b32 s52, s94, 10
    s_add_u32 s52, s52, 1048576
    s_lshl_b32 s53, s78, 3
    s_lshl_b32 s82, s81, 2
    s_add_u32 s53, s53, s82
    s_lshl_b32 s53, s53, 10
    s_lshl_b32 s82, s49, 8
    s_add_u32 s53, s53, s82
    s_add_u32 s53, s53, 1048576
    s_mul_i32 s54, s50, 20
    s_add_u32 s54, s54, s81
    s_sub_u32 s54, s54, 2
    s_lshl_b32 s54, s54, 13
    s_lshl_b32 s82, s78, 2
    s_add_u32 s82, s82, s49
    s_lshl_b32 s82, s82, 6
    s_add_u32 s54, s54, s82
    s_add_u32 s54, s54, 2097152
    s_add_u32 s55, s54, 49152
    s_add_u32 s56, s54, 98304
    s_add_u32 s50, s54, 147456
    s_lshl_b32 s57, s94, 13
    s_lshl_b32 s82, s81, 10
    s_add_u32 s57, s57, s82
    s_add_u32 s57, s57, 2097152
    s_cmp_ge_u32 s94, 40
    s_cselect_b32 s82, 40, 0
    s_cselect_b32 s83, 1280, 0
    s_sub_u32 s58, s94, s82
    s_lshl_b32 s58, s58, 5
    s_add_u32 s58, s58, s83
    s_mov_b32 s82, s86
    s_cmp_lt_u32 s82, 64
    s_cbranch_scc1 L_sbB
    s_cmp_lt_u32 s82, 96
    s_cbranch_scc1 L_ssB
    s_cmp_lt_u32 s81, 2
    s_cbranch_scc1 L_nodma2
    s_add_u32 m0, s59, 0
    s_nop 0
    buffer_load_dwordx4 v232, s[36:39], 0 offen nt lds
    s_add_u32 m0, s59, 6144
    s_nop 0
    buffer_load_dwordx4 v233, s[36:39], 0 offen nt lds
    s_add_u32 m0, s59, 12288
    s_nop 0
    buffer_load_dwordx4 v234, s[36:39], 0 offen nt lds
    s_add_u32 m0, s59, 18432
    s_nop 0
    buffer_load_dwordx4 v235, s[36:39], 0 offen nt lds
    s_add_u32 m0, s59, 24576
    s_nop 0
    buffer_load_dwordx4 v236, s[36:39], 0 offen nt lds
L_nodma2:
    v_mov_b32 v11, v6
    s_nop 1
    v_add_f32_dpp v11, v11, v11 row_ror:8 row_mask:0xf bank_mask:0xf
    v_mov_b32 v9, v11
    s_nop 1
    v_permlane16_swap_b32 v11, v9
    v_add_f32 v11, v11, v9
    v_mov_b32 v9, v11
    s_nop 1
    v_permlane32_swap_b32 v11, v9
    v_add_f32 v11, v11, v9
    v_mul_f32 v10, 0x3fb8aa3b, v7
    s_mov_b64 exec, 1
    ds_write_b32 v237, v11 offset:33536
    ds_write_b32 v238, v10 offset:41984
    s_mov_b64 exec, -1
    s_branch L_vdone
L_sbB:
    s_mul_i32 s84, s82, 6144
    s_add_u32 s84, s84, 1081344
    s_add_u32 s85, s84, 3072
    buffer_load_dwordx4 v[64:67], v8, s[20:23], s84 offen offset:0 nt
    buffer_load_dwordx4 v[68:71], v8, s[20:23], s84 offen offset:128 nt
    buffer_load_dwordx4 v[72:75], v8, s[20:23], s84 offen offset:256 nt
    buffer_load_dwordx4 v[76:79], v8, s[20:23], s85 offen offset:0 nt
    buffer_load_dwordx4 v[80:83], v8, s[20:23], s85 offen offset:128 nt
    buffer_load_dwordx4 v[84:87], v8, s[20:23], s85 offen offset:256 nt
    buffer_load_dwordx4 v[88:91], v8, s[24:27], s84 offen offset:0 nt
    buffer_load_dwordx4 v[92:95], v8, s[24:27], s84 offen offset:128 nt
    buffer_load_dwordx4 v[96:99], v8, s[24:27], s84 offen offset:256 nt
    buffer_load_dwordx4 v[100:103], v8, s[24:27], s85 offen offset:0 nt
    buffer_load_dwordx4 v[104:107], v8, s[24:27], s85 offen offset:128 nt
    buffer_load_dwordx4 v[108:111], v8, s[24:27], s85 offen offset:256 nt
    v_mov_b32 v39, 1
    v_mov_b32 v38, 0
    s_mov_b64 exec, 1
    buffer_atomic_add v39, v38, s[40:43], s51 offen sc0 sc1
    s_mov_b64 exec, -1
    s_branch L_bodyXB
L_ssB:
    s_mul_i32 s84, s82, 3072
    s_add_u32 s84, s84, 1277952
    buffer_load_dwordx4 v[64:67], v8, s[20:23], s84 offen offset:0 nt
    buffer_load_dwordx4 v[68:71], v8, s[20:23], s84 offen offset:128 nt
    buffer_load_dwordx4 v[72:75], v8, s[20:23], s84 offen offset:256 nt
    buffer_load_dwordx4 v[88:91], v8, s[24:27], s84 offen offset:0 nt
    buffer_load_dwordx4 v[92:95], v8, s[24:27], s84 offen offset:128 nt
    buffer_load_dwordx4 v[96:99], v8, s[24:27], s84 offen offset:256 nt
    v_mov_b32 v39, 1
    v_mov_b32 v38, 0
    s_mov_b64 exec, 1
    buffer_atomic_add v39, v38, s[40:43], s51 offen sc0 sc1
    s_mov_b64 exec, -1
    s_branch L_bodyXS
L_bodyXB:
    v_mov_b32 v24, 0
    v_mov_b32 v25, 0
    s_waitcnt vmcnt(7)
    v_dot2c_f32_bf16 v24, v64, v12
    v_dot2c_f32_bf16 v25, v76, v12
    v_dot2c_f32_bf16 v24, v65, v13
    v_dot2c_f32_bf16 v25, v77, v13
    v_dot2c_f32_bf16 v24, v66, v14
    v_dot2c_f32_bf16 v25, v78, v14
    v_dot2c_f32_bf16 v24, v67, v15
    v_dot2c_f32_bf16 v25, v79, v15
    v_dot2c_f32_bf16 v24, v68, v16
    v_dot2c_f32_bf16 v25, v80, v16
    v_dot2c_f32_bf16 v24, v69, v17
    v_dot2c_f32_bf16 v25, v81, v17
    v_dot2c_f32_bf16 v24, v70, v18
    v_dot2c_f32_bf16 v25, v82, v18
    v_dot2c_f32_bf16 v24, v71, v19
    v_dot2c_f32_bf16 v25, v83, v19
    v_dot2c_f32_bf16 v24, v72, v20
    v_dot2c_f32_bf16 v25, v84, v20
    v_dot2c_f32_bf16 v24, v73, v21
    v_dot2c_f32_bf16 v25, v85, v21
    v_dot2c_f32_bf16 v24, v74, v22
    v_dot2c_f32_bf16 v25, v86, v22
    v_dot2c_f32_bf16 v24, v75, v23
    v_dot2c_f32_bf16 v25, v87, v23
    s_nop 2
    v_add_f32_dpp v24, v24, v24 quad_perm:[1,0,3,2] row_mask:0xf bank_mask:0xf
    v_add_f32_dpp v25, v25, v25 quad_perm:[1,0,3,2] row_mask:0xf bank_mask:0xf
    s_nop 0
    v_add_f32_dpp v24, v24, v24 quad_perm:[2,3,0,1] row_mask:0xf bank_mask:0xf
    v_add_f32_dpp v25, v25, v25 quad_perm:[2,3,0,1] row_mask:0xf bank_mask:0xf
    s_nop 0
    v_add_f32_dpp v24, v24, v24 row_half_mirror row_mask:0xf bank_mask:0xf
    v_add_f32_dpp v25, v25, v25 row_half_mirror row_mask:0xf bank_mask:0xf
    s_nop 0
    v_cvt_pk_bf16_f32 v26, v24, v25
    v_lshlrev_b32 v24, 16, v26
    v_and_b32 v25, 0xffff0000, v26
    v_mul_f32 v24, 0x3d93cd3a, v24
    v_mul_f32 v25, 0x3d93cd3a, v25
    v_cvt_pk_bf16_f32 v26, v24, v25
    v_lshlrev_b32 v24, 16, v26
    v_and_b32 v25, 0xffff0000, v26
    v_max_f32 v27, v24, v25
    s_nop 1
    v_max_f32_dpp v27, v27, v27 row_ror:8 row_mask:0xf bank_mask:0xf
    v_mov_b32 v28, v27
    s_nop 1
    v_permlane16_swap_b32 v27, v28
    v_max_f32 v27, v27, v28
    v_mov_b32 v28, v27
    s_nop 1
    v_permlane32_swap_b32 v27, v28
    v_max_f32 v27, v27, v28
    v_cmp_gt_f32 vcc, v27, v7
    s_nop 4
    s_cmp_eq_u64 vcc, 0
    s_cbranch_scc1 L_norsXB
    v_sub_f32 v28, v7, v27
    v_mul_f32 v28, 0x3fb8aa3b, v28
    v_exp_f32 v28, v28
    v_mov_b32 v7, v27
    v_mul_f32 v6, v28, v6
    v_mul_f32 v40, v28, v40
    v_mul_f32 v41, v28, v41
    v_mul_f32 v42, v28, v42
    v_mul_f32 v43, v28, v43
    v_mul_f32 v44, v28, v44
    v_mul_f32 v45, v28, v45
    v_mul_f32 v46, v28, v46
    v_mul_f32 v47, v28, v47
    v_mul_f32 v48, v28, v48
    v_mul_f32 v49, v28, v49
    v_mul_f32 v50, v28, v50
    v_mul_f32 v51, v28, v51
    v_mul_f32 v52, v28, v52
    v_mul_f32 v53, v28, v53
    v_mul_f32 v54, v28, v54
    v_mul_f32 v55, v28, v55
    v_mul_f32 v56, v28, v56
    v_mul_f32 v57, v28, v57
    v_mul_f32 v58, v28, v58
    v_mul_f32 v59, v28, v59
    v_mul_f32 v60, v28, v60
    v_mul_f32 v61, v28, v61
    v_mul_f32 v62, v28, v62
    v_mul_f32 v63, v28, v63
L_norsXB:
    v_sub_f32 v24, v24, v7
    v_sub_f32 v25, v25, v7
    v_mul_f32 v24, 0x3fb8aa3b, v24
    v_mul_f32 v25, 0x3fb8aa3b, v25
    v_exp_f32 v24, v24
    v_exp_f32 v25, v25
    s_nop 0
    v_add_f32 v6, v6, v24
    v_add_f32 v6, v6, v25
    v_cvt_pk_bf16_f32 v26, v24, v25
    v_and_b32 v27, 0xffff, v26
    v_lshlrev_b32 v28, 16, v26
    v_lshrrev_b32 v29, 16, v26
    v_and_b32 v30, 0xffff0000, v26
    v_mov_b32 v11, v6
    s_nop 1
    v_add_f32_dpp v11, v11, v11 row_ror:8 row_mask:0xf bank_mask:0xf
    v_mov_b32 v9, v11
    s_nop 1
    v_permlane16_swap_b32 v11, v9
    v_add_f32 v11, v11, v9
    v_mov_b32 v9, v11
    s_nop 1
    v_permlane32_swap_b32 v11, v9
    v_add_f32 v11, v11, v9
    v_mul_f32 v10, 0x3fb8aa3b, v7
    s_mov_b64 exec, 1
    ds_write_b32 v237, v11 offset:33536
    ds_write_b32 v238, v10 offset:41984
    s_mov_b64 exec, -1
    s_waitcnt vmcnt(0)
    v_readfirstlane_b32 s82, v39
    s_nop 3
    s_cmp_lt_u32 s82, 64
    s_cbranch_scc1 L_nbXB
    s_cmp_lt_u32 s82, 96
    s_cbranch_scc1 L_nsXB
    s_cmp_lt_u32 s81, 2
    s_cbranch_scc1 L_nodma3
    s_add_u32 m0, s59, 0
    s_nop 0
    buffer_load_dwordx4 v232, s[36:39], 0 offen nt lds
    s_add_u32 m0, s59, 6144
    s_nop 0
    buffer_load_dwordx4 v233, s[36:39], 0 offen nt lds
    s_add_u32 m0, s59, 12288
    s_nop 0
    buffer_load_dwordx4 v234, s[36:39], 0 offen nt lds
    s_add_u32 m0, s59, 18432
    s_nop 0
    buffer_load_dwordx4 v235, s[36:39], 0 offen nt lds
    s_add_u32 m0, s59, 24576
    s_nop 0
    buffer_load_dwordx4 v236, s[36:39], 0 offen nt lds
L_nodma3:
    v_dot2c_f32_bf16 v40, v88, v27
    v_dot2c_f32_bf16 v41, v88, v28
    v_dot2c_f32_bf16 v42, v89, v27
    v_dot2c_f32_bf16 v43, v89, v28
    v_dot2c_f32_bf16 v44, v90, v27
    v_dot2c_f32_bf16 v45, v90, v28
    v_dot2c_f32_bf16 v46, v91, v27
    v_dot2c_f32_bf16 v47, v91, v28
    v_dot2c_f32_bf16 v48, v92, v27
    v_dot2c_f32_bf16 v49, v92, v28
    v_dot2c_f32_bf16 v50, v93, v27
    v_dot2c_f32_bf16 v51, v93, v28
    v_dot2c_f32_bf16 v52, v94, v27
    v_dot2c_f32_bf16 v53, v94, v28
    v_dot2c_f32_bf16 v54, v95, v27
    v_dot2c_f32_bf16 v55, v95, v28
    v_dot2c_f32_bf16 v56, v96, v27
    v_dot2c_f32_bf16 v57, v96, v28
    v_dot2c_f32_bf16 v58, v97, v27
    v_dot2c_f32_bf16 v59, v97, v28
    v_dot2c_f32_bf16 v60, v98, v27
    v_dot2c_f32_bf16 v61, v98, v28
    v_dot2c_f32_bf16 v62, v99, v27
    v_dot2c_f32_bf16 v63, v99, v28
    v_dot2c_f32_bf16 v40, v100, v29
    v_dot2c_f32_bf16 v41, v100, v30
    v_dot2c_f32_bf16 v42, v101, v29
    v_dot2c_f32_bf16 v43, v101, v30
    v_dot2c_f32_bf16 v44, v102, v29
    v_dot2c_f32_bf16 v45, v102, v30
    v_dot2c_f32_bf16 v46, v103, v29
    v_dot2c_f32_bf16 v47, v103, v30
    v_dot2c_f32_bf16 v48, v104, v29
    v_dot2c_f32_bf16 v49, v104, v30
    v_dot2c_f32_bf16 v50, v105, v29
    v_dot2c_f32_bf16 v51, v105, v30
    v_dot2c_f32_bf16 v52, v106, v29
    v_dot2c_f32_bf16 v53, v106, v30
    v_dot2c_f32_bf16 v54, v107, v29
    v_dot2c_f32_bf16 v55, v107, v30
    v_dot2c_f32_bf16 v56, v108, v29
    v_dot2c_f32_bf16 v57, v108, v30
    v_dot2c_f32_bf16 v58, v109, v29
    v_dot2c_f32_bf16 v59, v109, v30
    v_dot2c_f32_bf16 v60, v110, v29
    v_dot2c_f32_bf16 v61, v110, v30
    v_dot2c_f32_bf16 v62, v111, v29
    v_dot2c_f32_bf16 v63, v111, v30
    s_branch L_vdone
L_nbXB:
    s_mul_i32 s84, s82, 6144
    s_add_u32 s84, s84, 1081344
    s_add_u32 s85, s84, 3072
    buffer_load_dwordx4 v[112:115], v8, s[20:23], s84 offen offset:0 nt
    buffer_load_dwordx4 v[116:119], v8, s[20:23], s84 offen offset:128 nt
    buffer_load_dwordx4 v[120:123], v8, s[20:23], s84 offen offset:256 nt
    buffer_load_dwordx4 v[124:127], v8, s[20:23], s85 offen offset:0 nt
    buffer_load_dwordx4 v[128:131], v8, s[20:23], s85 offen offset:128 nt
    buffer_load_dwordx4 v[132:135], v8, s[20:23], s85 offen offset:256 nt
    buffer_load_dwordx4 v[136:139], v8, s[24:27], s84 offen offset:0 nt
    buffer_load_dwordx4 v[140:143], v8, s[24:27], s84 offen offset:128 nt
    buffer_load_dwordx4 v[144:147], v8, s[24:27], s84 offen offset:256 nt
    buffer_load_dwordx4 v[148:151], v8, s[24:27], s85 offen offset:0 nt
    buffer_load_dwordx4 v[152:155], v8, s[24:27], s85 offen offset:128 nt
    buffer_load_dwordx4 v[156:159], v8, s[24:27], s85 offen offset:256 nt
    v_mov_b32 v39, 1
    v_mov_b32 v38, 0
    s_mov_b64 exec, 1
    buffer_atomic_add v39, v38, s[40:43], s51 offen sc0 sc1
    s_mov_b64 exec, -1
    v_dot2c_f32_bf16 v40, v88, v27
    v_dot2c_f32_bf16 v41, v88, v28
    v_dot2c_f32_bf16 v42, v89, v27
    v_dot2c_f32_bf16 v43, v89, v28
    v_dot2c_f32_bf16 v44, v90, v27
    v_dot2c_f32_bf16 v45, v90, v28
    v_dot2c_f32_bf16 v46, v91, v27
    v_dot2c_f32_bf16 v47, v91, v28
    v_dot2c_f32_bf16 v48, v92, v27
    v_dot2c_f32_bf16 v49, v92, v28
    v_dot2c_f32_bf16 v50, v93, v27
    v_dot2c_f32_bf16 v51, v93, v28
    v_dot2c_f32_bf16 v52, v94, v27
    v_dot2c_f32_bf16 v53, v94, v28
    v_dot2c_f32_bf16 v54, v95, v27
    v_dot2c_f32_bf16 v55, v95, v28
    v_dot2c_f32_bf16 v56, v96, v27
    v_dot2c_f32_bf16 v57, v96, v28
    v_dot2c_f32_bf16 v58, v97, v27
    v_dot2c_f32_bf16 v59, v97, v28
    v_dot2c_f32_bf16 v60, v98, v27
    v_dot2c_f32_bf16 v61, v98, v28
    v_dot2c_f32_bf16 v62, v99, v27
    v_dot2c_f32_bf16 v63, v99, v28
    v_dot2c_f32_bf16 v40, v100, v29
    v_dot2c_f32_bf16 v41, v100, v30
    v_dot2c_f32_bf16 v42, v101, v29
    v_dot2c_f32_bf16 v43, v101, v30
    v_dot2c_f32_bf16 v44, v102, v29
    v_dot2c_f32_bf16 v45, v102, v30
    v_dot2c_f32_bf16 v46, v103, v29
    v_dot2c_f32_bf16 v47, v103, v30
    v_dot2c_f32_bf16 v48, v104, v29
    v_dot2c_f32_bf16 v49, v104, v30
    v_dot2c_f32_bf16 v50, v105, v29
    v_dot2c_f32_bf16 v51, v105, v30
    v_dot2c_f32_bf16 v52, v106, v29
    v_dot2c_f32_bf16 v53, v106, v30
    v_dot2c_f32_bf16 v54, v107, v29
    v_dot2c_f32_bf16 v55, v107, v30
    v_dot2c_f32_bf16 v56, v108, v29
    v_dot2c_f32_bf16 v57, v108, v30
    v_dot2c_f32_bf16 v58, v109, v29
    v_dot2c_f32_bf16 v59, v109, v30
    v_dot2c_f32_bf16 v60, v110, v29
    v_dot2c_f32_bf16 v61, v110, v30
    v_dot2c_f32_bf16 v62, v111, v29
    v_dot2c_f32_bf16 v63, v111, v30
    s_branch L_bodyYB
L_nsXB:
    s_mul_i32 s84, s82, 3072
    s_add_u32 s84, s84, 1277952
    buffer_load_dwordx4 v[112:115], v8, s[20:23], s84 offen offset:0 nt
    buffer_load_dwordx4 v[116:119], v8, s[20:23], s84 offen offset:128 nt
    buffer_load_dwordx4 v[120:123], v8, s[20:23], s84 offen offset:256 nt
    buffer_load_dwordx4 v[136:139], v8, s[24:27], s84 offen offset:0 nt
    buffer_load_dwordx4 v[140:143], v8, s[24:27], s84 offen offset:128 nt
    buffer_load_dwordx4 v[144:147], v8, s[24:27], s84 offen offset:256 nt
    v_mov_b32 v39, 1
    v_mov_b32 v38, 0
    s_mov_b64 exec, 1
    buffer_atomic_add v39, v38, s[40:43], s51 offen sc0 sc1
    s_mov_b64 exec, -1
    v_dot2c_f32_bf16 v40, v88, v27
    v_dot2c_f32_bf16 v41, v88, v28
    v_dot2c_f32_bf16 v42, v89, v27
    v_dot2c_f32_bf16 v43, v89, v28
    v_dot2c_f32_bf16 v44, v90, v27
    v_dot2c_f32_bf16 v45, v90, v28
    v_dot2c_f32_bf16 v46, v91, v27
    v_dot2c_f32_bf16 v47, v91, v28
    v_dot2c_f32_bf16 v48, v92, v27
    v_dot2c_f32_bf16 v49, v92, v28
    v_dot2c_f32_bf16 v50, v93, v27
    v_dot2c_f32_bf16 v51, v93, v28
    v_dot2c_f32_bf16 v52, v94, v27
    v_dot2c_f32_bf16 v53, v94, v28
    v_dot2c_f32_bf16 v54, v95, v27
    v_dot2c_f32_bf16 v55, v95, v28
    v_dot2c_f32_bf16 v56, v96, v27
    v_dot2c_f32_bf16 v57, v96, v28
    v_dot2c_f32_bf16 v58, v97, v27
    v_dot2c_f32_bf16 v59, v97, v28
    v_dot2c_f32_bf16 v60, v98, v27
    v_dot2c_f32_bf16 v61, v98, v28
    v_dot2c_f32_bf16 v62, v99, v27
    v_dot2c_f32_bf16 v63, v99, v28
    v_dot2c_f32_bf16 v40, v100, v29
    v_dot2c_f32_bf16 v41, v100, v30
    v_dot2c_f32_bf16 v42, v101, v29
    v_dot2c_f32_bf16 v43, v101, v30
    v_dot2c_f32_bf16 v44, v102, v29
    v_dot2c_f32_bf16 v45, v102, v30
    v_dot2c_f32_bf16 v46, v103, v29
    v_dot2c_f32_bf16 v47, v103, v30
    v_dot2c_f32_bf16 v48, v104, v29
    v_dot2c_f32_bf16 v49, v104, v30
    v_dot2c_f32_bf16 v50, v105, v29
    v_dot2c_f32_bf16 v51, v105, v30
    v_dot2c_f32_bf16 v52, v106, v29
    v_dot2c_f32_bf16 v53, v106, v30
    v_dot2c_f32_bf16 v54, v107, v29
    v_dot2c_f32_bf16 v55, v107, v30
    v_dot2c_f32_bf16 v56, v108, v29
    v_dot2c_f32_bf16 v57, v108, v30
    v_dot2c_f32_bf16 v58, v109, v29
    v_dot2c_f32_bf16 v59, v109, v30
    v_dot2c_f32_bf16 v60, v110, v29
    v_dot2c_f32_bf16 v61, v110, v30
    v_dot2c_f32_bf16 v62, v111, v29
    v_dot2c_f32_bf16 v63, v111, v30
    s_branch L_bodyYS
L_bodyYB:
    v_mov_b32 v24, 0
    v_mov_b32 v25, 0
    s_waitcnt vmcnt(7)
    v_dot2c_f32_bf16 v24, v112, v12
    v_dot2c_f32_bf16 v25, v124, v12
    v_dot2c_f32_bf16 v24, v113, v13
    v_dot2c_f32_bf16 v25, v125, v13
    v_dot2c_f32_bf16 v24, v114, v14
    v_dot2c_f32_bf16 v25, v126, v14
    v_dot2c_f32_bf16 v24, v115, v15
    v_dot2c_f32_bf16 v25, v127, v15
    v_dot2c_f32_bf16 v24, v116, v16
    v_dot2c_f32_bf16 v25, v128, v16
    v_dot2c_f32_bf16 v24, v117, v17
    v_dot2c_f32_bf16 v25, v129, v17
    v_dot2c_f32_bf16 v24, v118, v18
    v_dot2c_f32_bf16 v25, v130, v18
    v_dot2c_f32_bf16 v24, v119, v19
    v_dot2c_f32_bf16 v25, v131, v19
    v_dot2c_f32_bf16 v24, v120, v20
    v_dot2c_f32_bf16 v25, v132, v20
    v_dot2c_f32_bf16 v24, v121, v21
    v_dot2c_f32_bf16 v25, v133, v21
    v_dot2c_f32_bf16 v24, v122, v22
    v_dot2c_f32_bf16 v25, v134, v22
    v_dot2c_f32_bf16 v24, v123, v23
    v_dot2c_f32_bf16 v25, v135, v23
    s_nop 2
    v_add_f32_dpp v24, v24, v24 quad_perm:[1,0,3,2] row_mask:0xf bank_mask:0xf
    v_add_f32_dpp v25, v25, v25 quad_perm:[1,0,3,2] row_mask:0xf bank_mask:0xf
    s_nop 0
    v_add_f32_dpp v24, v24, v24 quad_perm:[2,3,0,1] row_mask:0xf bank_mask:0xf
    v_add_f32_dpp v25, v25, v25 quad_perm:[2,3,0,1] row_mask:0xf bank_mask:0xf
    s_nop 0
    v_add_f32_dpp v24, v24, v24 row_half_mirror row_mask:0xf bank_mask:0xf
    v_add_f32_dpp v25, v25, v25 row_half_mirror row_mask:0xf bank_mask:0xf
    s_nop 0
    v_cvt_pk_bf16_f32 v26, v24, v25
    v_lshlrev_b32 v24, 16, v26
    v_and_b32 v25, 0xffff0000, v26
    v_mul_f32 v24, 0x3d93cd3a, v24
    v_mul_f32 v25, 0x3d93cd3a, v25
    v_cvt_pk_bf16_f32 v26, v24, v25
    v_lshlrev_b32 v24, 16, v26
    v_and_b32 v25, 0xffff0000, v26
    v_max_f32 v27, v24, v25
    s_nop 1
    v_max_f32_dpp v27, v27, v27 row_ror:8 row_mask:0xf bank_mask:0xf
    v_mov_b32 v28, v27
    s_nop 1
    v_permlane16_swap_b32 v27, v28
    v_max_f32 v27, v27, v28
    v_mov_b32 v28, v27
    s_nop 1
    v_permlane32_swap_b32 v27, v28
    v_max_f32 v27, v27, v28
    v_cmp_gt_f32 vcc, v27, v7
    s_nop 4
    s_cmp_eq_u64 vcc, 0
    s_cbranch_scc1 L_norsYB
    v_sub_f32 v28, v7, v27
    v_mul_f32 v28, 0x3fb8aa3b, v28
    v_exp_f32 v28, v28
    v_mov_b32 v7, v27
    v_mul_f32 v6, v28, v6
    v_mul_f32 v40, v28, v40
    v_mul_f32 v41, v28, v41
    v_mul_f32 v42, v28, v42
    v_mul_f32 v43, v28, v43
    v_mul_f32 v44, v28, v44
    v_mul_f32 v45, v28, v45
    v_mul_f32 v46, v28, v46
    v_mul_f32 v47, v28, v47
    v_mul_f32 v48, v28, v48
    v_mul_f32 v49, v28, v49
    v_mul_f32 v50, v28, v50
    v_mul_f32 v51, v28, v51
    v_mul_f32 v52, v28, v52
    v_mul_f32 v53, v28, v53
    v_mul_f32 v54, v28, v54
    v_mul_f32 v55, v28, v55
    v_mul_f32 v56, v28, v56
    v_mul_f32 v57, v28, v57
    v_mul_f32 v58, v28, v58
    v_mul_f32 v59, v28, v59
    v_mul_f32 v60, v28, v60
    v_mul_f32 v61, v28, v61
    v_mul_f32 v62, v28, v62
    v_mul_f32 v63, v28, v63
L_norsYB:
    v_sub_f32 v24, v24, v7
    v_sub_f32 v25, v25, v7
    v_mul_f32 v24, 0x3fb8aa3b, v24
    v_mul_f32 v25, 0x3fb8aa3b, v25
    v_exp_f32 v24, v24
    v_exp_f32 v25, v25
    s_nop 0
    v_add_f32 v6, v6, v24
    v_add_f32 v6, v6, v25
    v_cvt_pk_bf16_f32 v26, v24, v25
    v_and_b32 v27, 0xffff, v26
    v_lshlrev_b32 v28, 16, v26
    v_lshrrev_b32 v29, 16, v26
    v_and_b32 v30, 0xffff0000, v26
    v_mov_b32 v11, v6
    s_nop 1
    v_add_f32_dpp v11, v11, v11 row_ror:8 row_mask:0xf bank_mask:0xf
    v_mov_b32 v9, v11
    s_nop 1
    v_permlane16_swap_b32 v11, v9
    v_add_f32 v11, v11, v9
    v_mov_b32 v9, v11
    s_nop 1
    v_permlane32_swap_b32 v11, v9
    v_add_f32 v11, v11, v9
    v_mul_f32 v10, 0x3fb8aa3b, v7
    s_mov_b64 exec, 1
    ds_write_b32 v237, v11 offset:33536
    ds_write_b32 v238, v10 offset:41984
    s_mov_b64 exec, -1
    s_waitcnt vmcnt(0)
    v_readfirstlane_b32 s82, v39
    s_nop 3
    s_cmp_lt_u32 s82, 64
    s_cbranch_scc1 L_nbYB
    s_cmp_lt_u32 s82, 96
    s_cbranch_scc1 L_nsYB
    s_cmp_lt_u32 s81, 2
    s_cbranch_scc1 L_nodma4
    s_add_u32 m0, s59, 0
    s_nop 0
    buffer_load_dwordx4 v232, s[36:39], 0 offen nt lds
    s_add_u32 m0, s59, 6144
    s_nop 0
    buffer_load_dwordx4 v233, s[36:39], 0 offen nt lds
    s_add_u32 m0, s59, 12288
    s_nop 0
    buffer_load_dwordx4 v234, s[36:39], 0 offen nt lds
    s_add_u32 m0, s59, 18432
    s_nop 0
    buffer_load_dwordx4 v235, s[36:39], 0 offen nt lds
    s_add_u32 m0, s59, 24576
    s_nop 0
    buffer_load_dwordx4 v236, s[36:39], 0 offen nt lds
L_nodma4:
    v_dot2c_f32_bf16 v40, v136, v27
    v_dot2c_f32_bf16 v41, v136, v28
    v_dot2c_f32_bf16 v42, v137, v27
    v_dot2c_f32_bf16 v43, v137, v28
    v_dot2c_f32_bf16 v44, v138, v27
    v_dot2c_f32_bf16 v45, v138, v28
    v_dot2c_f32_bf16 v46, v139, v27
    v_dot2c_f32_bf16 v47, v139, v28
    v_dot2c_f32_bf16 v48, v140, v27
    v_dot2c_f32_bf16 v49, v140, v28
    v_dot2c_f32_bf16 v50, v141, v27
    v_dot2c_f32_bf16 v51, v141, v28
    v_dot2c_f32_bf16 v52, v142, v27
    v_dot2c_f32_bf16 v53, v142, v28
    v_dot2c_f32_bf16 v54, v143, v27
    v_dot2c_f32_bf16 v55, v143, v28
    v_dot2c_f32_bf16 v56, v144, v27
    v_dot2c_f32_bf16 v57, v144, v28
    v_dot2c_f32_bf16 v58, v145, v27
    v_dot2c_f32_bf16 v59, v145, v28
    v_dot2c_f32_bf16 v60, v146, v27
    v_dot2c_f32_bf16 v61, v146, v28
    v_dot2c_f32_bf16 v62, v147, v27
    v_dot2c_f32_bf16 v63, v147, v28
    v_dot2c_f32_bf16 v40, v148, v29
    v_dot2c_f32_bf16 v41, v148, v30
    v_dot2c_f32_bf16 v42, v149, v29
    v_dot2c_f32_bf16 v43, v149, v30
    v_dot2c_f32_bf16 v44, v150, v29
    v_dot2c_f32_bf16 v45, v150, v30
    v_dot2c_f32_bf16 v46, v151, v29
    v_dot2c_f32_bf16 v47, v151, v30
    v_dot2c_f32_bf16 v48, v152, v29
    v_dot2c_f32_bf16 v49, v152, v30
    v_dot2c_f32_bf16 v50, v153, v29
    v_dot2c_f32_bf16 v51, v153, v30
    v_dot2c_f32_bf16 v52, v154, v29
    v_dot2c_f32_bf16 v53, v154, v30
    v_dot2c_f32_bf16 v54, v155, v29
    v_dot2c_f32_bf16 v55, v155, v30
    v_dot2c_f32_bf16 v56, v156, v29
    v_dot2c_f32_bf16 v57, v156, v30
    v_dot2c_f32_bf16 v58, v157, v29
    v_dot2c_f32_bf16 v59, v157, v30
    v_dot2c_f32_bf16 v60, v158, v29
    v_dot2c_f32_bf16 v61, v158, v30
    v_dot2c_f32_bf16 v62, v159, v29
    v_dot2c_f32_bf16 v63, v159, v30
    s_branch L_vdone
L_nbYB:
    s_mul_i32 s84, s82, 6144
    s_add_u32 s84, s84, 1081344
    s_add_u32 s85, s84, 3072
    buffer_load_dwordx4 v[64:67], v8, s[20:23], s84 offen offset:0 nt
    buffer_load_dwordx4 v[68:71], v8, s[20:23], s84 offen offset:128 nt
    buffer_load_dwordx4 v[72:75], v8, s[20:23], s84 offen offset:256 nt
    buffer_load_dwordx4 v[76:79], v8, s[20:23], s85 offen offset:0 nt
    buffer_load_dwordx4 v[80:83], v8, s[20:23], s85 offen offset:128 nt
    buffer_load_dwordx4 v[84:87], v8, s[20:23], s85 offen offset:256 nt
    buffer_load_dwordx4 v[88:91], v8, s[24:27], s84 offen offset:0 nt
    buffer_load_dwordx4 v[92:95], v8, s[24:27], s84 offen offset:128 nt
    buffer_load_dwordx4 v[96:99], v8, s[24:27], s84 offen offset:256 nt
    buffer_load_dwordx4 v[100:103], v8, s[24:27], s85 offen offset:0 nt
    buffer_load_dwordx4 v[104:107], v8, s[24:27], s85 offen offset:128 nt
    buffer_load_dwordx4 v[108:111], v8, s[24:27], s85 offen offset:256 nt
    v_mov_b32 v39, 1
    v_mov_b32 v38, 0
    s_mov_b64 exec, 1
    buffer_atomic_add v39, v38, s[40:43], s51 offen sc0 sc1
    s_mov_b64 exec, -1
    v_dot2c_f32_bf16 v40, v136, v27
    v_dot2c_f32_bf16 v41, v136, v28
    v_dot2c_f32_bf16 v42, v137, v27
    v_dot2c_f32_bf16 v43, v137, v28
    v_dot2c_f32_bf16 v44, v138, v27
    v_dot2c_f32_bf16 v45, v138, v28
    v_dot2c_f32_bf16 v46, v139, v27
    v_dot2c_f32_bf16 v47, v139, v28
    v_dot2c_f32_bf16 v48, v140, v27
    v_dot2c_f32_bf16 v49, v140, v28
    v_dot2c_f32_bf16 v50, v141, v27
    v_dot2c_f32_bf16 v51, v141, v28
    v_dot2c_f32_bf16 v52, v142, v27
    v_dot2c_f32_bf16 v53, v142, v28
    v_dot2c_f32_bf16 v54, v143, v27
    v_dot2c_f32_bf16 v55, v143, v28
    v_dot2c_f32_bf16 v56, v144, v27
    v_dot2c_f32_bf16 v57, v144, v28
    v_dot2c_f32_bf16 v58, v145, v27
    v_dot2c_f32_bf16 v59, v145, v28
    v_dot2c_f32_bf16 v60, v146, v27
    v_dot2c_f32_bf16 v61, v146, v28
    v_dot2c_f32_bf16 v62, v147, v27
    v_dot2c_f32_bf16 v63, v147, v28
    v_dot2c_f32_bf16 v40, v148, v29
    v_dot2c_f32_bf16 v41, v148, v30
    v_dot2c_f32_bf16 v42, v149, v29
    v_dot2c_f32_bf16 v43, v149, v30
    v_dot2c_f32_bf16 v44, v150, v29
    v_dot2c_f32_bf16 v45, v150, v30
    v_dot2c_f32_bf16 v46, v151, v29
    v_dot2c_f32_bf16 v47, v151, v30
    v_dot2c_f32_bf16 v48, v152, v29
    v_dot2c_f32_bf16 v49, v152, v30
    v_dot2c_f32_bf16 v50, v153, v29
    v_dot2c_f32_bf16 v51, v153, v30
    v_dot2c_f32_bf16 v52, v154, v29
    v_dot2c_f32_bf16 v53, v154, v30
    v_dot2c_f32_bf16 v54, v155, v29
    v_dot2c_f32_bf16 v55, v155, v30
    v_dot2c_f32_bf16 v56, v156, v29
    v_dot2c_f32_bf16 v57, v156, v30
    v_dot2c_f32_bf16 v58, v157, v29
    v_dot2c_f32_bf16 v59, v157, v30
    v_dot2c_f32_bf16 v60, v158, v29
    v_dot2c_f32_bf16 v61, v158, v30
    v_dot2c_f32_bf16 v62, v159, v29
    v_dot2c_f32_bf16 v63, v159, v30
    s_branch L_bodyXB
L_nsYB:
    s_mul_i32 s84, s82, 3072
    s_add_u32 s84, s84, 1277952
    buffer_load_dwordx4 v[64:67], v8, s[20:23], s84 offen offset:0 nt
    buffer_load_dwordx4 v[68:71], v8, s[20:23], s84 offen offset:128 nt
    buffer_load_dwordx4 v[72:75], v8, s[20:23], s84 offen offset:256 nt
    buffer_load_dwordx4 v[88:91], v8, s[24:27], s84 offen offset:0 nt
    buffer_load_dwordx4 v[92:95], v8, s[24:27], s84 offen offset:128 nt
    buffer_load_dwordx4 v[96:99], v8, s[24:27], s84 offen offset:256 nt
    v_mov_b32 v39, 1
    v_mov_b32 v38, 0
    s_mov_b64 exec, 1
    buffer_atomic_add v39, v38, s[40:43], s51 offen sc0 sc1
    s_mov_b64 exec, -1
    v_dot2c_f32_bf16 v40, v136, v27
    v_dot2c_f32_bf16 v41, v136, v28
    v_dot2c_f32_bf16 v42, v137, v27
    v_dot2c_f32_bf16 v43, v137, v28
    v_dot2c_f32_bf16 v44, v138, v27
    v_dot2c_f32_bf16 v45, v138, v28
    v_dot2c_f32_bf16 v46, v139, v27
    v_dot2c_f32_bf16 v47, v139, v28
    v_dot2c_f32_bf16 v48, v140, v27
    v_dot2c_f32_bf16 v49, v140, v28
    v_dot2c_f32_bf16 v50, v141, v27
    v_dot2c_f32_bf16 v51, v141, v28
    v_dot2c_f32_bf16 v52, v142, v27
    v_dot2c_f32_bf16 v53, v142, v28
    v_dot2c_f32_bf16 v54, v143, v27
    v_dot2c_f32_bf16 v55, v143, v28
    v_dot2c_f32_bf16 v56, v144, v27
    v_dot2c_f32_bf16 v57, v144, v28
    v_dot2c_f32_bf16 v58, v145, v27
    v_dot2c_f32_bf16 v59, v145, v28
    v_dot2c_f32_bf16 v60, v146, v27
    v_dot2c_f32_bf16 v61, v146, v28
    v_dot2c_f32_bf16 v62, v147, v27
    v_dot2c_f32_bf16 v63, v147, v28
    v_dot2c_f32_bf16 v40, v148, v29
    v_dot2c_f32_bf16 v41, v148, v30
    v_dot2c_f32_bf16 v42, v149, v29
    v_dot2c_f32_bf16 v43, v149, v30
    v_dot2c_f32_bf16 v44, v150, v29
    v_dot2c_f32_bf16 v45, v150, v30
    v_dot2c_f32_bf16 v46, v151, v29
    v_dot2c_f32_bf16 v47, v151, v30
    v_dot2c_f32_bf16 v48, v152, v29
    v_dot2c_f32_bf16 v49, v152, v30
    v_dot2c_f32_bf16 v50, v153, v29
    v_dot2c_f32_bf16 v51, v153, v30
    v_dot2c_f32_bf16 v52, v154, v29
    v_dot2c_f32_bf16 v53, v154, v30
    v_dot2c_f32_bf16 v54, v155, v29
    v_dot2c_f32_bf16 v55, v155, v30
    v_dot2c_f32_bf16 v56, v156, v29
    v_dot2c_f32_bf16 v57, v156, v30
    v_dot2c_f32_bf16 v58, v157, v29
    v_dot2c_f32_bf16 v59, v157, v30
    v_dot2c_f32_bf16 v60, v158, v29
    v_dot2c_f32_bf16 v61, v158, v30
    v_dot2c_f32_bf16 v62, v159, v29
    v_dot2c_f32_bf16 v63, v159, v30
    s_branch L_bodyXS
L_bodyXS:
    v_mov_b32 v24, 0
    v_mov_b32 v25, 0
    s_waitcnt vmcnt(4)
    v_dot2c_f32_bf16 v24, v64, v12
    v_dot2c_f32_bf16 v25, v70, v18
    v_dot2c_f32_bf16 v24, v65, v13
    v_dot2c_f32_bf16 v25, v71, v19
    v_dot2c_f32_bf16 v24, v66, v14
    v_dot2c_f32_bf16 v25, v72, v20
    v_dot2c_f32_bf16 v24, v67, v15
    v_dot2c_f32_bf16 v25, v73, v21
    v_dot2c_f32_bf16 v24, v68, v16
    v_dot2c_f32_bf16 v25, v74, v22
    v_dot2c_f32_bf16 v24, v69, v17
    v_dot2c_f32_bf16 v25, v75, v23
    s_nop 2
    v_add_f32 v24, v24, v25
    s_nop 1
    v_add_f32_dpp v24, v24, v24 quad_perm:[1,0,3,2] row_mask:0xf bank_mask:0xf
    s_nop 1
    v_add_f32_dpp v24, v24, v24 quad_perm:[2,3,0,1] row_mask:0xf bank_mask:0xf
    s_nop 1
    v_add_f32_dpp v24, v24, v24 row_half_mirror row_mask:0xf bank_mask:0xf
    v_cvt_pk_bf16_f32 v26, v24, v24
    v_and_b32 v24, 0xffff0000, v26
    v_mul_f32 v24, 0x3d93cd3a, v24
    v_cvt_pk_bf16_f32 v26, v24, v24
    v_and_b32 v24, 0xffff0000, v26
    v_mov_b32 v27, v24
    s_nop 1
    v_max_f32_dpp v27, v27, v27 row_ror:8 row_mask:0xf bank_mask:0xf
    v_mov_b32 v28, v27
    s_nop 1
    v_permlane16_swap_b32 v27, v28
    v_max_f32 v27, v27, v28
    v_mov_b32 v28, v27
    s_nop 1
    v_permlane32_swap_b32 v27, v28
    v_max_f32 v27, v27, v28
    v_cmp_gt_f32 vcc, v27, v7
    s_nop 4
    s_cmp_eq_u64 vcc, 0
    s_cbranch_scc1 L_norsXS
    v_sub_f32 v28, v7, v27
    v_mul_f32 v28, 0x3fb8aa3b, v28
    v_exp_f32 v28, v28
    v_mov_b32 v7, v27
    v_mul_f32 v6, v28, v6
    v_mul_f32 v40, v28, v40
    v_mul_f32 v41, v28, v41
    v_mul_f32 v42, v28, v42
    v_mul_f32 v43, v28, v43
    v_mul_f32 v44, v28, v44
    v_mul_f32 v45, v28, v45
    v_mul_f32 v46, v28, v46
    v_mul_f32 v47, v28, v47
    v_mul_f32 v48, v28, v48
    v_mul_f32 v49, v28, v49
    v_mul_f32 v50, v28, v50
    v_mul_f32 v51, v28, v51
    v_mul_f32 v52, v28, v52
    v_mul_f32 v53, v28, v53
    v_mul_f32 v54, v28, v54
    v_mul_f32 v55, v28, v55
    v_mul_f32 v56, v28, v56
    v_mul_f32 v57, v28, v57
    v_mul_f32 v58, v28, v58
    v_mul_f32 v59, v28, v59
    v_mul_f32 v60, v28, v60
    v_mul_f32 v61, v28, v61
    v_mul_f32 v62, v28, v62
    v_mul_f32 v63, v28, v63
L_norsXS:
    v_sub_f32 v24, v24, v7
    v_mul_f32 v24, 0x3fb8aa3b, v24
    v_exp_f32 v24, v24
    s_nop 0
    v_add_f32 v6, v6, v24
    v_cvt_pk_bf16_f32 v26, v24, v24
    v_and_b32 v27, 0xffff, v26
    v_lshlrev_b32 v28, 16, v26
    v_mov_b32 v11, v6
    s_nop 1
    v_add_f32_dpp v11, v11, v11 row_ror:8 row_mask:0xf bank_mask:0xf
    v_mov_b32 v9, v11
    s_nop 1
    v_permlane16_swap_b32 v11, v9
    v_add_f32 v11, v11, v9
    v_mov_b32 v9, v11
    s_nop 1
    v_permlane32_swap_b32 v11, v9
    v_add_f32 v11, v11, v9
    v_mul_f32 v10, 0x3fb8aa3b, v7
    s_mov_b64 exec, 1
    ds_write_b32 v237, v11 offset:33536
    ds_write_b32 v238, v10 offset:41984
    s_mov_b64 exec, -1
    s_waitcnt vmcnt(0)
    v_readfirstlane_b32 s82, v39
    s_nop 3
    s_cmp_lt_u32 s82, 64
    s_cbranch_scc1 L_nbXS
    s_cmp_lt_u32 s82, 96
    s_cbranch_scc1 L_nsXS
    s_cmp_lt_u32 s81, 2
    s_cbranch_scc1 L_nodma5
    s_add_u32 m0, s59, 0
    s_nop 0
    buffer_load_dwordx4 v232, s[36:39], 0 offen nt lds
    s_add_u32 m0, s59, 6144
    s_nop 0
    buffer_load_dwordx4 v233, s[36:39], 0 offen nt lds
    s_add_u32 m0, s59, 12288
    s_nop 0
    buffer_load_dwordx4 v234, s[36:39], 0 offen nt lds
    s_add_u32 m0, s59, 18432
    s_nop 0
    buffer_load_dwordx4 v235, s[36:39], 0 offen nt lds
    s_add_u32 m0, s59, 24576
    s_nop 0
    buffer_load_dwordx4 v236, s[36:39], 0 offen nt lds
L_nodma5:
    v_dot2c_f32_bf16 v40, v88, v27
    v_dot2c_f32_bf16 v41, v88, v28
    v_dot2c_f32_bf16 v42, v89, v27
    v_dot2c_f32_bf16 v43, v89, v28
    v_dot2c_f32_bf16 v44, v90, v27
    v_dot2c_f32_bf16 v45, v90, v28
    v_dot2c_f32_bf16 v46, v91, v27
    v_dot2c_f32_bf16 v47, v91, v28
    v_dot2c_f32_bf16 v48, v92, v27
    v_dot2c_f32_bf16 v49, v92, v28
    v_dot2c_f32_bf16 v50, v93, v27
    v_dot2c_f32_bf16 v51, v93, v28
    v_dot2c_f32_bf16 v52, v94, v27
    v_dot2c_f32_bf16 v53, v94, v28
    v_dot2c_f32_bf16 v54, v95, v27
    v_dot2c_f32_bf16 v55, v95, v28
    v_dot2c_f32_bf16 v56, v96, v27
    v_dot2c_f32_bf16 v57, v96, v28
    v_dot2c_f32_bf16 v58, v97, v27
    v_dot2c_f32_bf16 v59, v97, v28
    v_dot2c_f32_bf16 v60, v98, v27
    v_dot2c_f32_bf16 v61, v98, v28
    v_dot2c_f32_bf16 v62, v99, v27
    v_dot2c_f32_bf16 v63, v99, v28
    s_branch L_vdone
L_nbXS:
    s_mul_i32 s84, s82, 6144
    s_add_u32 s84, s84, 1081344
    s_add_u32 s85, s84, 3072
    buffer_load_dwordx4 v[112:115], v8, s[20:23], s84 offen offset:0 nt
    buffer_load_dwordx4 v[116:119], v8, s[20:23], s84 offen offset:128 nt
    buffer_load_dwordx4 v[120:123], v8, s[20:23], s84 offen offset:256 nt
    buffer_load_dwordx4 v[124:127], v8, s[20:23], s85 offen offset:0 nt
    buffer_load_dwordx4 v[128:131], v8, s[20:23], s85 offen offset:128 nt
    buffer_load_dwordx4 v[132:135], v8, s[20:23], s85 offen offset:256 nt
    buffer_load_dwordx4 v[136:139], v8, s[24:27], s84 offen offset:0 nt
    buffer_load_dwordx4 v[140:143], v8, s[24:27], s84 offen offset:128 nt
    buffer_load_dwordx4 v[144:147], v8, s[24:27], s84 offen offset:256 nt
    buffer_load_dwordx4 v[148:151], v8, s[24:27], s85 offen offset:0 nt
    buffer_load_dwordx4 v[152:155], v8, s[24:27], s85 offen offset:128 nt
    buffer_load_dwordx4 v[156:159], v8, s[24:27], s85 offen offset:256 nt
    v_mov_b32 v39, 1
    v_mov_b32 v38, 0
    s_mov_b64 exec, 1
    buffer_atomic_add v39, v38, s[40:43], s51 offen sc0 sc1
    s_mov_b64 exec, -1
    v_dot2c_f32_bf16 v40, v88, v27
    v_dot2c_f32_bf16 v41, v88, v28
    v_dot2c_f32_bf16 v42, v89, v27
    v_dot2c_f32_bf16 v43, v89, v28
    v_dot2c_f32_bf16 v44, v90, v27
    v_dot2c_f32_bf16 v45, v90, v28
    v_dot2c_f32_bf16 v46, v91, v27
    v_dot2c_f32_bf16 v47, v91, v28
    v_dot2c_f32_bf16 v48, v92, v27
    v_dot2c_f32_bf16 v49, v92, v28
    v_dot2c_f32_bf16 v50, v93, v27
    v_dot2c_f32_bf16 v51, v93, v28
    v_dot2c_f32_bf16 v52, v94, v27
    v_dot2c_f32_bf16 v53, v94, v28
    v_dot2c_f32_bf16 v54, v95, v27
    v_dot2c_f32_bf16 v55, v95, v28
    v_dot2c_f32_bf16 v56, v96, v27
    v_dot2c_f32_bf16 v57, v96, v28
    v_dot2c_f32_bf16 v58, v97, v27
    v_dot2c_f32_bf16 v59, v97, v28
    v_dot2c_f32_bf16 v60, v98, v27
    v_dot2c_f32_bf16 v61, v98, v28
    v_dot2c_f32_bf16 v62, v99, v27
    v_dot2c_f32_bf16 v63, v99, v28
    s_branch L_bodyYB
L_nsXS:
    s_mul_i32 s84, s82, 3072
    s_add_u32 s84, s84, 1277952
    buffer_load_dwordx4 v[112:115], v8, s[20:23], s84 offen offset:0 nt
    buffer_load_dwordx4 v[116:119], v8, s[20:23], s84 offen offset:128 nt
    buffer_load_dwordx4 v[120:123], v8, s[20:23], s84 offen offset:256 nt
    buffer_load_dwordx4 v[136:139], v8, s[24:27], s84 offen offset:0 nt
    buffer_load_dwordx4 v[140:143], v8, s[24:27], s84 offen offset:128 nt
    buffer_load_dwordx4 v[144:147], v8, s[24:27], s84 offen offset:256 nt
    v_mov_b32 v39, 1
    v_mov_b32 v38, 0
    s_mov_b64 exec, 1
    buffer_atomic_add v39, v38, s[40:43], s51 offen sc0 sc1
    s_mov_b64 exec, -1
    v_dot2c_f32_bf16 v40, v88, v27
    v_dot2c_f32_bf16 v41, v88, v28
    v_dot2c_f32_bf16 v42, v89, v27
    v_dot2c_f32_bf16 v43, v89, v28
    v_dot2c_f32_bf16 v44, v90, v27
    v_dot2c_f32_bf16 v45, v90, v28
    v_dot2c_f32_bf16 v46, v91, v27
    v_dot2c_f32_bf16 v47, v91, v28
    v_dot2c_f32_bf16 v48, v92, v27
    v_dot2c_f32_bf16 v49, v92, v28
    v_dot2c_f32_bf16 v50, v93, v27
    v_dot2c_f32_bf16 v51, v93, v28
    v_dot2c_f32_bf16 v52, v94, v27
    v_dot2c_f32_bf16 v53, v94, v28
    v_dot2c_f32_bf16 v54, v95, v27
    v_dot2c_f32_bf16 v55, v95, v28
    v_dot2c_f32_bf16 v56, v96, v27
    v_dot2c_f32_bf16 v57, v96, v28
    v_dot2c_f32_bf16 v58, v97, v27
    v_dot2c_f32_bf16 v59, v97, v28
    v_dot2c_f32_bf16 v60, v98, v27
    v_dot2c_f32_bf16 v61, v98, v28
    v_dot2c_f32_bf16 v62, v99, v27
    v_dot2c_f32_bf16 v63, v99, v28
    s_branch L_bodyYS
L_bodyYS:
    v_mov_b32 v24, 0
    v_mov_b32 v25, 0
    s_waitcnt vmcnt(4)
    v_dot2c_f32_bf16 v24, v112, v12
    v_dot2c_f32_bf16 v25, v118, v18
    v_dot2c_f32_bf16 v24, v113, v13
    v_dot2c_f32_bf16 v25, v119, v19
    v_dot2c_f32_bf16 v24, v114, v14
    v_dot2c_f32_bf16 v25, v120, v20
    v_dot2c_f32_bf16 v24, v115, v15
    v_dot2c_f32_bf16 v25, v121, v21
    v_dot2c_f32_bf16 v24, v116, v16
    v_dot2c_f32_bf16 v25, v122, v22
    v_dot2c_f32_bf16 v24, v117, v17
    v_dot2c_f32_bf16 v25, v123, v23
    s_nop 2
    v_add_f32 v24, v24, v25
    s_nop 1
    v_add_f32_dpp v24, v24, v24 quad_perm:[1,0,3,2] row_mask:0xf bank_mask:0xf
    s_nop 1
    v_add_f32_dpp v24, v24, v24 quad_perm:[2,3,0,1] row_mask:0xf bank_mask:0xf
    s_nop 1
    v_add_f32_dpp v24, v24, v24 row_half_mirror row_mask:0xf bank_mask:0xf
    v_cvt_pk_bf16_f32 v26, v24, v24
    v_and_b32 v24, 0xffff0000, v26
    v_mul_f32 v24, 0x3d93cd3a, v24
    v_cvt_pk_bf16_f32 v26, v24, v24
    v_and_b32 v24, 0xffff0000, v26
    v_mov_b32 v27, v24
    s_nop 1
    v_max_f32_dpp v27, v27, v27 row_ror:8 row_mask:0xf bank_mask:0xf
    v_mov_b32 v28, v27
    s_nop 1
    v_permlane16_swap_b32 v27, v28
    v_max_f32 v27, v27, v28
    v_mov_b32 v28, v27
    s_nop 1
    v_permlane32_swap_b32 v27, v28
    v_max_f32 v27, v27, v28
    v_cmp_gt_f32 vcc, v27, v7
    s_nop 4
    s_cmp_eq_u64 vcc, 0
    s_cbranch_scc1 L_norsYS
    v_sub_f32 v28, v7, v27
    v_mul_f32 v28, 0x3fb8aa3b, v28
    v_exp_f32 v28, v28
    v_mov_b32 v7, v27
    v_mul_f32 v6, v28, v6
    v_mul_f32 v40, v28, v40
    v_mul_f32 v41, v28, v41
    v_mul_f32 v42, v28, v42
    v_mul_f32 v43, v28, v43
    v_mul_f32 v44, v28, v44
    v_mul_f32 v45, v28, v45
    v_mul_f32 v46, v28, v46
    v_mul_f32 v47, v28, v47
    v_mul_f32 v48, v28, v48
    v_mul_f32 v49, v28, v49
    v_mul_f32 v50, v28, v50
    v_mul_f32 v51, v28, v51
    v_mul_f32 v52, v28, v52
    v_mul_f32 v53, v28, v53
    v_mul_f32 v54, v28, v54
    v_mul_f32 v55, v28, v55
    v_mul_f32 v56, v28, v56
    v_mul_f32 v57, v28, v57
    v_mul_f32 v58, v28, v58
    v_mul_f32 v59, v28, v59
    v_mul_f32 v60, v28, v60
    v_mul_f32 v61, v28, v61
    v_mul_f32 v62, v28, v62
    v_mul_f32 v63, v28, v63
L_norsYS:
    v_sub_f32 v24, v24, v7
    v_mul_f32 v24, 0x3fb8aa3b, v24
    v_exp_f32 v24, v24
    s_nop 0
    v_add_f32 v6, v6, v24
    v_cvt_pk_bf16_f32 v26, v24, v24
    v_and_b32 v27, 0xffff, v26
    v_lshlrev_b32 v28, 16, v26
    v_mov_b32 v11, v6
    s_nop 1
    v_add_f32_dpp v11, v11, v11 row_ror:8 row_mask:0xf bank_mask:0xf
    v_mov_b32 v9, v11
    s_nop 1
    v_permlane16_swap_b32 v11, v9
    v_add_f32 v11, v11, v9
    v_mov_b32 v9, v11
    s_nop 1
    v_permlane32_swap_b32 v11, v9
    v_add_f32 v11, v11, v9
    v_mul_f32 v10, 0x3fb8aa3b, v7
    s_mov_b64 exec, 1
    ds_write_b32 v237, v11 offset:33536
    ds_write_b32 v238, v10 offset:41984
    s_mov_b64 exec, -1
    s_waitcnt vmcnt(0)
    v_readfirstlane_b32 s82, v39
    s_nop 3
    s_cmp_lt_u32 s82, 64
    s_cbranch_scc1 L_nbYS
    s_cmp_lt_u32 s82, 96
    s_cbranch_scc1 L_nsYS
    s_cmp_lt_u32 s81, 2
    s_cbranch_scc1 L_nodma6
    s_add_u32 m0, s59, 0
    s_nop 0
    buffer_load_dwordx4 v232, s[36:39], 0 offen nt lds
    s_add_u32 m0, s59, 6144
    s_nop 0
    buffer_load_dwordx4 v233, s[36:39], 0 offen nt lds
    s_add_u32 m0, s59, 12288
    s_nop 0
    buffer_load_dwordx4 v234, s[36:39], 0 offen nt lds
    s_add_u32 m0, s59, 18432
    s_nop 0
    buffer_load_dwordx4 v235, s[36:39], 0 offen nt lds
    s_add_u32 m0, s59, 24576
    s_nop 0
    buffer_load_dwordx4 v236, s[36:39], 0 offen nt lds
L_nodma6:
    v_dot2c_f32_bf16 v40, v136, v27
    v_dot2c_f32_bf16 v41, v136, v28
    v_dot2c_f32_bf16 v42, v137, v27
    v_dot2c_f32_bf16 v43, v137, v28
    v_dot2c_f32_bf16 v44, v138, v27
    v_dot2c_f32_bf16 v45, v138, v28
    v_dot2c_f32_bf16 v46, v139, v27
    v_dot2c_f32_bf16 v47, v139, v28
    v_dot2c_f32_bf16 v48, v140, v27
    v_dot2c_f32_bf16 v49, v140, v28
    v_dot2c_f32_bf16 v50, v141, v27
    v_dot2c_f32_bf16 v51, v141, v28
    v_dot2c_f32_bf16 v52, v142, v27
    v_dot2c_f32_bf16 v53, v142, v28
    v_dot2c_f32_bf16 v54, v143, v27
    v_dot2c_f32_bf16 v55, v143, v28
    v_dot2c_f32_bf16 v56, v144, v27
    v_dot2c_f32_bf16 v57, v144, v28
    v_dot2c_f32_bf16 v58, v145, v27
    v_dot2c_f32_bf16 v59, v145, v28
    v_dot2c_f32_bf16 v60, v146, v27
    v_dot2c_f32_bf16 v61, v146, v28
    v_dot2c_f32_bf16 v62, v147, v27
    v_dot2c_f32_bf16 v63, v147, v28
    s_branch L_vdone
L_nbYS:
    s_mul_i32 s84, s82, 6144
    s_add_u32 s84, s84, 1081344
    s_add_u32 s85, s84, 3072
    buffer_load_dwordx4 v[64:67], v8, s[20:23], s84 offen offset:0 nt
    buffer_load_dwordx4 v[68:71], v8, s[20:23], s84 offen offset:128 nt
    buffer_load_dwordx4 v[72:75], v8, s[20:23], s84 offen offset:256 nt
    buffer_load_dwordx4 v[76:79], v8, s[20:23], s85 offen offset:0 nt
    buffer_load_dwordx4 v[80:83], v8, s[20:23], s85 offen offset:128 nt
    buffer_load_dwordx4 v[84:87], v8, s[20:23], s85 offen offset:256 nt
    buffer_load_dwordx4 v[88:91], v8, s[24:27], s84 offen offset:0 nt
    buffer_load_dwordx4 v[92:95], v8, s[24:27], s84 offen offset:128 nt
    buffer_load_dwordx4 v[96:99], v8, s[24:27], s84 offen offset:256 nt
    buffer_load_dwordx4 v[100:103], v8, s[24:27], s85 offen offset:0 nt
    buffer_load_dwordx4 v[104:107], v8, s[24:27], s85 offen offset:128 nt
    buffer_load_dwordx4 v[108:111], v8, s[24:27], s85 offen offset:256 nt
    v_mov_b32 v39, 1
    v_mov_b32 v38, 0
    s_mov_b64 exec, 1
    buffer_atomic_add v39, v38, s[40:43], s51 offen sc0 sc1
    s_mov_b64 exec, -1
    v_dot2c_f32_bf16 v40, v136, v27
    v_dot2c_f32_bf16 v41, v136, v28
    v_dot2c_f32_bf16 v42, v137, v27
    v_dot2c_f32_bf16 v43, v137, v28
    v_dot2c_f32_bf16 v44, v138, v27
    v_dot2c_f32_bf16 v45, v138, v28
    v_dot2c_f32_bf16 v46, v139, v27
    v_dot2c_f32_bf16 v47, v139, v28
    v_dot2c_f32_bf16 v48, v140, v27
    v_dot2c_f32_bf16 v49, v140, v28
    v_dot2c_f32_bf16 v50, v141, v27
    v_dot2c_f32_bf16 v51, v141, v28
    v_dot2c_f32_bf16 v52, v142, v27
    v_dot2c_f32_bf16 v53, v142, v28
    v_dot2c_f32_bf16 v54, v143, v27
    v_dot2c_f32_bf16 v55, v143, v28
    v_dot2c_f32_bf16 v56, v144, v27
    v_dot2c_f32_bf16 v57, v144, v28
    v_dot2c_f32_bf16 v58, v145, v27
    v_dot2c_f32_bf16 v59, v145, v28
    v_dot2c_f32_bf16 v60, v146, v27
    v_dot2c_f32_bf16 v61, v146, v28
    v_dot2c_f32_bf16 v62, v147, v27
    v_dot2c_f32_bf16 v63, v147, v28
    s_branch L_bodyXB
L_nsYS:
    s_mul_i32 s84, s82, 3072
    s_add_u32 s84, s84, 1277952
    buffer_load_dwordx4 v[64:67], v8, s[20:23], s84 offen offset:0 nt
    buffer_load_dwordx4 v[68:71], v8, s[20:23], s84 offen offset:128 nt
    buffer_load_dwordx4 v[72:75], v8, s[20:23], s84 offen offset:256 nt
    buffer_load_dwordx4 v[88:91], v8, s[24:27], s84 offen offset:0 nt
    buffer_load_dwordx4 v[92:95], v8, s[24:27], s84 offen offset:128 nt
    buffer_load_dwordx4 v[96:99], v8, s[24:27], s84 offen offset:256 nt
    v_mov_b32 v39, 1
    v_mov_b32 v38, 0
    s_mov_b64 exec, 1
    buffer_atomic_add v39, v38, s[40:43], s51 offen sc0 sc1
    s_mov_b64 exec, -1
    v_dot2c_f32_bf16 v40, v136, v27
    v_dot2c_f32_bf16 v41, v136, v28
    v_dot2c_f32_bf16 v42, v137, v27
    v_dot2c_f32_bf16 v43, v137, v28
    v_dot2c_f32_bf16 v44, v138, v27
    v_dot2c_f32_bf16 v45, v138, v28
    v_dot2c_f32_bf16 v46, v139, v27
    v_dot2c_f32_bf16 v47, v139, v28
    v_dot2c_f32_bf16 v48, v140, v27
    v_dot2c_f32_bf16 v49, v140, v28
    v_dot2c_f32_bf16 v50, v141, v27
    v_dot2c_f32_bf16 v51, v141, v28
    v_dot2c_f32_bf16 v52, v142, v27
    v_dot2c_f32_bf16 v53, v142, v28
    v_dot2c_f32_bf16 v54, v143, v27
    v_dot2c_f32_bf16 v55, v143, v28
    v_dot2c_f32_bf16 v56, v144, v27
    v_dot2c_f32_bf16 v57, v144, v28
    v_dot2c_f32_bf16 v58, v145, v27
    v_dot2c_f32_bf16 v59, v145, v28
    v_dot2c_f32_bf16 v60, v146, v27
    v_dot2c_f32_bf16 v61, v146, v28
    v_dot2c_f32_bf16 v62, v147, v27
    v_dot2c_f32_bf16 v63, v147, v28
    s_branch L_bodyXS
L_vdone:
    s_nop 2
    v_permlane32_swap_b32 v40, v44
    v_permlane32_swap_b32 v41, v45
    v_permlane32_swap_b32 v42, v46
    v_permlane32_swap_b32 v43, v47
    v_permlane32_swap_b32 v48, v52
    v_permlane32_swap_b32 v49, v53
    v_permlane32_swap_b32 v50, v54
    v_permlane32_swap_b32 v51, v55
    v_permlane32_swap_b32 v56, v60
    v_permlane32_swap_b32 v57, v61
    v_permlane32_swap_b32 v58, v62
    v_permlane32_swap_b32 v59, v63
    v_add_f32 v40, v40, v44
    v_add_f32 v41, v41, v45
    v_add_f32 v42, v42, v46
    v_add_f32 v43, v43, v47
    v_add_f32 v48, v48, v52
    v_add_f32 v49, v49, v53
    v_add_f32 v50, v50, v54
    v_add_f32 v51, v51, v55
    v_add_f32 v56, v56, v60
    v_add_f32 v57, v57, v61
    v_add_f32 v58, v58, v62
    v_add_f32 v59, v59, v63
    s_nop 1
    v_permlane16_swap_b32 v40, v42
    v_permlane16_swap_b32 v41, v43
    v_permlane16_swap_b32 v48, v50
    v_permlane16_swap_b32 v49, v51
    v_permlane16_swap_b32 v56, v58
    v_permlane16_swap_b32 v57, v59
    v_add_f32 v40, v40, v42
    v_add_f32 v41, v41, v43
    v_add_f32 v48, v48, v50
    v_add_f32 v49, v49, v51
    v_add_f32 v56, v56, v58
    v_add_f32 v57, v57, v59
    s_nop 1
    v_add_f32_dpp v40, v40, v40 row_ror:8 row_mask:0xf bank_mask:0x3
    v_add_f32_dpp v48, v48, v48 row_ror:8 row_mask:0xf bank_mask:0x3
    v_add_f32_dpp v56, v56, v56 row_ror:8 row_mask:0xf bank_mask:0x3
    v_add_f32_dpp v40, v41, v41 row_ror:8 row_mask:0xf bank_mask:0xc
    v_add_f32_dpp v48, v49, v49 row_ror:8 row_mask:0xf bank_mask:0xc
    v_add_f32_dpp v56, v57, v57 row_ror:8 row_mask:0xf bank_mask:0xc
    ds_write_b32 v5, v40 offset:32768
    ds_write_b32 v5, v48 offset:33024
    ds_write_b32 v5, v56 offset:33280
    s_waitcnt lgkmcnt(0)
    s_barrier
    s_cmp_eq_u32 s81, 0
    s_cbranch_scc0 L_nopub
    ds_read_b128 v[24:27], v251 offset:41984
    ds_read_b128 v[28:31], v251 offset:42000
    ds_read_b128 v[160:163], v244 offset:32768
    ds_read_b128 v[164:167], v244 offset:33792
    ds_read_b128 v[168:171], v244 offset:34816
    ds_read_b128 v[172:175], v244 offset:35840
    ds_read_b128 v[176:179], v244 offset:36864
    ds_read_b128 v[180:183], v244 offset:37888
    ds_read_b128 v[184:187], v244 offset:38912
    ds_read_b128 v[188:191], v244 offset:39936
    s_waitcnt lgkmcnt(8)
    v_max3_f32 v32, v24, v25, v26
    v_max3_f32 v33, v27, v28, v29
    v_max3_f32 v32, v32, v30, v31
    v_max_f32 v32, v32, v33
    v_and_b32 v32, 0xffffff00, v32
    v_sub_f32 v24, v24, v32
    v_sub_f32 v25, v25, v32
    v_sub_f32 v26, v26, v32
    v_sub_f32 v27, v27, v32
    v_sub_f32 v28, v28, v32
    v_sub_f32 v29, v29, v32
    v_sub_f32 v30, v30, v32
    v_sub_f32 v31, v31, v32
    v_exp_f32 v24, v24
    v_exp_f32 v25, v25
    v_exp_f32 v26, v26
    v_exp_f32 v27, v27
    v_exp_f32 v28, v28
    v_exp_f32 v29, v29
    v_exp_f32 v30, v30
    v_exp_f32 v31, v31
    s_waitcnt lgkmcnt(6)
    v_mul_f32 v36, v24, v160
    v_mul_f32 v37, v24, v161
    v_mul_f32 v38, v24, v162
    v_mul_f32 v39, v24, v163
    v_mul_f32 v40, v25, v164
    v_mul_f32 v41, v25, v165
    v_mul_f32 v42, v25, v166
    v_mul_f32 v43, v25, v167
    s_waitcnt lgkmcnt(4)
    v_fmac_f32 v36, v26, v168
    v_fmac_f32 v37, v26, v169
    v_fmac_f32 v38, v26, v170
    v_fmac_f32 v39, v26, v171
    v_fmac_f32 v40, v27, v172
    v_fmac_f32 v41, v27, v173
    v_fmac_f32 v42, v27, v174
    v_fmac_f32 v43, v27, v175
    s_waitcnt lgkmcnt(2)
    v_fmac_f32 v36, v28, v176
    v_fmac_f32 v37, v28, v177
    v_fmac_f32 v38, v28, v178
    v_fmac_f32 v39, v28, v179
    v_fmac_f32 v40, v29, v180
    v_fmac_f32 v41, v29, v181
    v_fmac_f32 v42, v29, v182
    v_fmac_f32 v43, v29, v183
    s_waitcnt lgkmcnt(0)
    v_fmac_f32 v36, v30, v184
    v_fmac_f32 v37, v30, v185
    v_fmac_f32 v38, v30, v186
    v_fmac_f32 v39, v30, v187
    v_fmac_f32 v40, v31, v188
    v_fmac_f32 v41, v31, v189
    v_fmac_f32 v42, v31, v190
    v_fmac_f32 v43, v31, v191
    v_add_f32 v36, v36, v40
    v_add_f32 v37, v37, v41
    v_add_f32 v38, v38, v42
    v_add_f32 v39, v39, v43
    s_mov_b32 exec_lo, 0x10001000
    s_mov_b32 exec_hi, 0x10001000
    v_mov_b32 v37, v32
    s_mov_b64 exec, -1
    v_bfi_b32 v36, v4, v3, v36
    v_bfi_b32 v37, v4, v3, v37
    v_bfi_b32 v38, v4, v3, v38
    v_bfi_b32 v39, v4, v3, v39
    buffer_store_dwordx4 v[36:39], v245, s[40:43], s52 offen sc1
L_nopub:
    s_cmp_lt_u32 s81, 2
    s_cbranch_scc1 L_pollers
    v_mov_b32 v9, 1
    s_waitcnt vmcnt(0)
    s_mov_b64 exec, 1
    ds_add_u32 v251, v9 offset:42080
    s_mov_b64 exec, -1
    s_mov_b32 s95, 0
L_dwait:
    ds_read_b32 v10, v251 offset:42080
    s_waitcnt lgkmcnt(0)
    v_cmp_ne_u32 vcc, 6, v10
    s_nop 4
    s_cmp_eq_u64 vcc, 0
    s_cbranch_scc1 L_dok
    s_add_u32 s95, s95, 1
    s_cmp_gt_u32 s95, 2097152
    s_cbranch_scc1 L_dok
    s_sleep 1
    s_branch L_dwait
L_dok:
    ds_read_b64_tr_b16 v[64:65], v250 offset:0
    ds_read_b64_tr_b16 v[70:71], v250 offset:192
    ds_read_b64_tr_b16 v[76:77], v250 offset:384
    ds_read_b64_tr_b16 v[82:83], v250 offset:576
    ds_read_b64_tr_b16 v[66:67], v250 offset:10240
    ds_read_b64_tr_b16 v[72:73], v250 offset:10432
    ds_read_b64_tr_b16 v[78:79], v250 offset:10624
    ds_read_b64_tr_b16 v[84:85], v250 offset:10816
    ds_read_b64_tr_b16 v[68:69], v250 offset:20480
    ds_read_b64_tr_b16 v[74:75], v250 offset:20672
    ds_read_b64_tr_b16 v[80:81], v250 offset:20864
    ds_read_b64_tr_b16 v[86:87], v250 offset:21056
    s_branch L_h1done
L_pollers:
    s_mov_b32 s60, -1
    s_mov_b32 s61, -1
    s_mov_b32 s95, 0
L_h1poll:
    s_mov_b64 exec, s[60:61]
    buffer_load_dwordx4 v[88:91], v246, s[40:43], s53 offen sc1
    s_waitcnt vmcnt(0)
    v_cmp_ne_u32_sdwa s[60:61], v88, v3 src0_sel:BYTE_0 src1_sel:BYTE_0
    v_cmp_ne_u32_sdwa s[62:63], v89, v3 src0_sel:BYTE_0 src1_sel:BYTE_0
    v_cmp_ne_u32_sdwa s[64:65], v90, v3 src0_sel:BYTE_0 src1_sel:BYTE_0
    v_cmp_ne_u32_sdwa s[66:67], v91, v3 src0_sel:BYTE_0 src1_sel:BYTE_0
    s_nop 3
    s_or_b64 s[62:63], s[62:63], s[64:65]
    s_or_b64 s[60:61], s[60:61], s[66:67]
    s_or_b64 s[60:61], s[60:61], s[62:63]
    s_lshr_b64 s[62:63], s[60:61], 1
    s_or_b64 s[60:61], s[60:61], s[62:63]
    s_lshr_b64 s[62:63], s[60:61], 2
    s_or_b64 s[60:61], s[60:61], s[62:63]
    s_and_b32 s60, s60, 0x11111111
    s_and_b32 s61, s61, 0x11111111
    s_mul_i32 s60, s60, 15
    s_mul_i32 s61, s61, 15
    s_or_b32 s62, s60, s61
    s_cbranch_scc0 L_h1ok
    s_add_u32 s95, s95, 1
    s_cmp_gt_u32 s95, 131072
    s_cbranch_scc1 L_h1ok
    s_sleep 1
    s_branch L_h1poll
L_h1ok:
    s_mov_b64 exec, -1
    v_mov_b32_dpp v40, v88 row_newbcast:12 row_mask:0xf bank_mask:0xf
    v_mov_b32_dpp v41, v89 row_newbcast:12 row_mask:0xf bank_mask:0xf
    v_and_b32 v41, 0xffffff00, v41
    v_mov_b32 v42, v41
    v_mov_b32 v43, v42
    s_nop 1
    v_permlane16_swap_b32 v42, v43
    v_max_f32 v42, v42, v43
    v_mov_b32 v43, v42
    s_nop 1
    v_permlane32_swap_b32 v42, v43
    v_max_f32 v42, v42, v43
    v_sub_f32 v41, v41, v42
    v_exp_f32 v41, v41
    s_nop 0
    v_mul_f32 v40, v41, v40
    v_mul_f32 v92, v41, v88
    v_mul_f32 v93, v41, v89
    v_mul_f32 v94, v41, v90
    v_mul_f32 v95, v41, v91
    v_mov_b32 v43, v40
    s_nop 0
    v_permlane32_swap_b32 v92, v94
    v_permlane32_swap_b32 v93, v95
    v_permlane16_swap_b32 v40, v43
    v_add_f32 v92, v92, v94
    v_add_f32 v93, v93, v95
    v_add_f32 v40, v40, v43
    v_mov_b32 v43, v40
    s_nop 0
    v_permlane16_swap_b32 v92, v93
    v_permlane32_swap_b32 v40, v43
    v_add_f32 v92, v92, v93
    v_add_f32 v40, v40, v43
    v_rcp_f32 v40, v40
    s_nop 0
    v_mul_f32 v92, v92, v40
    v_cvt_pk_bf16_f32 v92, v92, v92
    s_mov_b32 exec_lo, 0x0fff0fff
    s_mov_b32 exec_hi, 0x0fff0fff
    ds_write_b16 v247, v92 offset:41472
    s_mov_b64 exec, -1
L_h1done:
    s_waitcnt lgkmcnt(0)
    s_barrier
    s_cmp_lt_u32 s81, 2
    s_cbranch_scc1 L_nomfma
    ds_read_b64 v[112:113], v248 offset:41472
    ds_read_b64 v[114:115], v248 offset:41504
    ds_read_b64 v[116:117], v248 offset:41536
    s_waitcnt lgkmcnt(2)
    v_mfma_f32_16x16x16_bf16 v[40:43], v[64:65], v[112:113], 0
    v_mfma_f32_16x16x16_bf16 v[44:47], v[70:71], v[112:113], 0
    v_mfma_f32_16x16x16_bf16 v[48:51], v[76:77], v[112:113], 0
    v_mfma_f32_16x16x16_bf16 v[52:55], v[82:83], v[112:113], 0
    s_waitcnt lgkmcnt(1)
    v_mfma_f32_16x16x16_bf16 v[40:43], v[66:67], v[114:115], v[40:43]
    v_mfma_f32_16x16x16_bf16 v[44:47], v[72:73], v[114:115], v[44:47]
    v_mfma_f32_16x16x16_bf16 v[48:51], v[78:79], v[114:115], v[48:51]
    v_mfma_f32_16x16x16_bf16 v[52:55], v[84:85], v[114:115], v[52:55]
    s_waitcnt lgkmcnt(0)
    v_mfma_f32_16x16x16_bf16 v[40:43], v[68:69], v[116:117], v[40:43]
    v_mfma_f32_16x16x16_bf16 v[44:47], v[74:75], v[116:117], v[44:47]
    v_mfma_f32_16x16x16_bf16 v[48:51], v[80:81], v[116:117], v[48:51]
    v_mfma_f32_16x16x16_bf16 v[52:55], v[86:87], v[116:117], v[52:55]
    s_mov_b32 exec_lo, 0x00030003
    s_mov_b32 exec_hi, 0x00030003
    s_nop 2
    v_bfi_b32 v40, v4, v3, v40
    v_bfi_b32 v41, v4, v3, v41
    v_bfi_b32 v42, v4, v3, v42
    v_bfi_b32 v43, v4, v3, v43
    buffer_store_dwordx4 v[40:43], v249, s[40:43], s54 offen sc1
    v_bfi_b32 v44, v4, v3, v44
    v_bfi_b32 v45, v4, v3, v45
    v_bfi_b32 v46, v4, v3, v46
    v_bfi_b32 v47, v4, v3, v47
    buffer_store_dwordx4 v[44:47], v249, s[40:43], s55 offen sc1
    v_bfi_b32 v48, v4, v3, v48
    v_bfi_b32 v49, v4, v3, v49
    v_bfi_b32 v50, v4, v3, v50
    v_bfi_b32 v51, v4, v3, v51
    buffer_store_dwordx4 v[48:51], v249, s[40:43], s56 offen sc1
    s_cmp_lt_u32 s81, 4
    s_cbranch_scc0 L_no3
    v_bfi_b32 v52, v4, v3, v52
    v_bfi_b32 v53, v4, v3, v53
    v_bfi_b32 v54, v4, v3, v54
    v_bfi_b32 v55, v4, v3, v55
    buffer_store_dwordx4 v[52:55], v249, s[40:43], s50 offen sc1
L_no3:
    s_mov_b64 exec, -1
L_nomfma:
    s_cmp_lt_u32 s94, 80
    s_cbranch_scc0 L_fin
    s_mov_b32 s60, -1
    s_mov_b32 s61, -1
    s_mov_b32 s95, 0
L_h2poll:
    s_mov_b64 exec, s[60:61]
    buffer_load_dwordx4 v[124:127], v245, s[40:43], s57 offen sc1
    s_waitcnt vmcnt(0)
    v_cmp_ne_u32_sdwa s[60:61], v124, v3 src0_sel:BYTE_0 src1_sel:BYTE_0
    v_cmp_ne_u32_sdwa s[62:63], v125, v3 src0_sel:BYTE_0 src1_sel:BYTE_0
    v_cmp_ne_u32_sdwa s[64:65], v126, v3 src0_sel:BYTE_0 src1_sel:BYTE_0
    v_cmp_ne_u32_sdwa s[66:67], v127, v3 src0_sel:BYTE_0 src1_sel:BYTE_0
    s_nop 3
    s_or_b64 s[62:63], s[62:63], s[64:65]
    s_or_b64 s[60:61], s[60:61], s[66:67]
    s_or_b64 s[60:61], s[60:61], s[62:63]
    s_lshr_b64 s[62:63], s[60:61], 1
    s_or_b64 s[60:61], s[60:61], s[62:63]
    s_lshr_b64 s[62:63], s[60:61], 2
    s_or_b64 s[60:61], s[60:61], s[62:63]
    s_and_b32 s60, s60, 0x11111111
    s_and_b32 s61, s61, 0x11111111
    s_mul_i32 s60, s60, 15
    s_mul_i32 s61, s61, 15
    s_or_b32 s62, s60, s61
    s_cbranch_scc0 L_h2ok
    s_add_u32 s95, s95, 1
    s_cmp_gt_u32 s95, 131072
    s_cbranch_scc1 L_h2ok
    s_sleep 1
    s_branch L_h2poll
L_h2ok:
    s_mov_b64 exec, -1
    v_mov_b32 v128, v124
    v_mov_b32 v129, v125
    v_mov_b32 v130, v126
    v_mov_b32 v131, v127
    s_nop 1
    v_permlane32_swap_b32 v128, v130
    v_permlane32_swap_b32 v129, v131
    v_add_f32 v128, v128, v130
    v_add_f32 v129, v129, v131
    s_nop 1
    v_permlane16_swap_b32 v128, v129
    v_add_f32 v128, v128, v129
    s_nop 1
    v_add_f32_dpp v128, v128, v128 row_ror:8 row_mask:0xf bank_mask:0xf
    s_nop 1
    v_add_f32_dpp v128, v128, v128 row_ror:4 row_mask:0xf bank_mask:0xf
    s_mov_b32 exec_lo, 0x000f000f
    s_mov_b32 exec_hi, 0x000f000f
    ds_write_b32 v252, v128 offset:32768
    s_mov_b64 exec, -1
    s_waitcnt lgkmcnt(0)
    s_barrier
    s_cmp_eq_u32 s81, 0
    s_cbranch_scc0 L_fin
    v_lshlrev_b32 v9, 2, v1
    v_add_u32 v11, 32768, v9
    ds_read2_b32 v[136:137], v11 offset0:0 offset1:16
    ds_read2_b32 v[138:139], v11 offset0:32 offset1:48
    ds_read2_b32 v[140:141], v11 offset0:64 offset1:80
    ds_read2_b32 v[142:143], v11 offset0:96 offset1:112
    v_lshlrev_b32 v10, 1, v1
    s_waitcnt lgkmcnt(0)
    v_add_f32 v136, v136, v137
    v_add_f32 v138, v138, v139
    v_add_f32 v140, v140, v141
    v_add_f32 v142, v142, v143
    v_add_f32 v136, v136, v138
    v_add_f32 v140, v140, v142
    v_add_f32 v136, v136, v140
    v_cvt_pk_bf16_f32 v136, v136, v136
    s_mov_b64 exec, 0xffff
    buffer_store_short v136, v10, s[44:47], s58 offen
    s_cmp_eq_u32 s94, 0
    s_cbranch_scc0 L_fin2
    v_mov_b32 v9, s48
    s_mov_b64 exec, 1
    buffer_store_dword v9, v251, s[40:43], 0 offen sc1
L_fin2:
    s_mov_b64 exec, -1
L_fin:
L_end:
    s_endpgm
.section .rodata,"a"
.p2align 6
.amdhsa_kernel standalone__sliding_block_cached__decode_kernel
  .amdhsa_next_free_vgpr 256
  .amdhsa_next_free_sgpr 102
  .amdhsa_accum_offset 256
  .amdhsa_group_segment_fixed_size 0
  .amdhsa_kernarg_size 64
  .amdhsa_user_sgpr_count 2
  .amdhsa_user_sgpr_kernarg_segment_ptr 1
  .amdhsa_system_sgpr_workgroup_id_x 1
.end_amdhsa_kernel
```
